```python
import torch

def _softmax(x, axis=-1):
    return torch.softmax(x, dim=axis)
def _gelu(x):
    return torch.nn.functional.gelu(x, approximate="tanh")
def _silu(x):
    return torch.nn.functional.silu(x)
def _sigmoid(x):
    return torch.sigmoid(x)
def _layernorm(x, axis=-1, eps=1e-5):
    m = x.mean(dim=axis, keepdim=True)
    v = x.var(dim=axis, keepdim=True, unbiased=False)
    return (x - m) / torch.sqrt(v + eps)
def _scatter_add(tgt, idx, src, axis=0):
    return tgt.clone().index_add_(axis, idx, src)
def _segment_sum(src, seg, n):
    out = torch.zeros((n,) + src.shape[1:], dtype=src.dtype)
    return out.index_add_(0, seg, src)
def _pad(x, pw):
    flat = tuple(v for pair in reversed(pw) for v in pair)
    return torch.nn.functional.pad(x, flat)

kernel_name = 'recurrent_scan__mha_block_cached__geglu_ffn__decode'

def setup_inputs():

    _w = (lambda a: (lambda t: t.to(torch.bfloat16) if t.is_floating_point() else t)(torch.as_tensor(a)))
    def _A_setup():
        B, Sq, D = 8, 1, 448
        H, Sk, Dh = 16, 4096, 256
        return {
            "x": _w((lambda *s: torch.randn(*s, dtype=torch.bfloat16) * 0.05)(B, Sq, D)),
            "k_cache": _w((lambda *s: torch.randn(*s, dtype=torch.bfloat16) * 1.6)(B, H, Sk, Dh)),
            "v_cache": _w((lambda *s: torch.randn(*s, dtype=torch.bfloat16) * 0.2)(B, H, Sk, Dh)),
            "wq": _w((lambda *s: torch.randn(*s, dtype=torch.bfloat16) * 1.6)(D, H * Dh) * (D ** -0.5)),
            "wo": _w((lambda *s: torch.randn(*s, dtype=torch.bfloat16) * 0.2)(H * Dh, D) * ((H * Dh) ** -0.5)),
        }
    _A_in = _A_setup()

    def _B_setup():
        B, S, D, F = 8, 1, 448, 1792
        return {
            "x": _w((lambda *s: torch.randn(*s, dtype=torch.bfloat16) * 0.05)(B, S, D)),
            "w_gate": _w((lambda *s: torch.randn(*s, dtype=torch.bfloat16) * 0.1)(D, F)),
            "w_up": _w((lambda *s: torch.randn(*s, dtype=torch.bfloat16) * 0.1)(D, F)),
            "w_down": _w((lambda *s: torch.randn(*s, dtype=torch.bfloat16) * 0.1)(F, D)),
        }
    _B_in = _B_setup()

    return {
        "A_x": _A_in["x"],
        "A_k_cache": _A_in["k_cache"],
        "A_v_cache": _A_in["v_cache"],
        "A_wq": _A_in["wq"],
        "A_wo": _A_in["wo"],
        "B_x": _B_in["x"],
        "B_w_gate": _B_in["w_gate"],
        "B_w_up": _B_in["w_up"],
        "B_w_down": _B_in["w_down"],
    }

def reference(A_x, A_k_cache, A_v_cache, A_wq, A_wo, B_x, B_w_gate, B_w_up, B_w_down):
    def _A_ref(x, k_cache, v_cache, wq, wo):
        B, Sq, D = x.shape
        H, Dh = 16, 256
        q = (lambda x, *d: x.permute(*d))((x @ wq).reshape(B, Sq, H, Dh), 0, 2, 1, 3)
        scores = torch.einsum("bhqd,bhkd->bhqk", q, k_cache) * (Dh ** -0.5)
        p = _softmax(scores, axis=-1)
        o = torch.einsum("bhqk,bhkd->bhqd", p, v_cache)
        return (lambda x, *d: x.permute(*d))(o, 0, 2, 1, 3).reshape(B, Sq, H * Dh) @ wo

    def _B_ref(x, w_gate, w_up, w_down):
        return (_gelu(x @ w_gate) * (x @ w_up)) @ w_down

    x = A_x
    xn = _layernorm(x, axis=-1)
    s = _A_ref(xn, A_k_cache, A_v_cache, A_wq, A_wo)
    g = _silu(_B_ref(xn, B_w_gate, B_w_up, B_w_down))
    return x + s * g
```

```asm
; @launch grid=(256,1,1) block=(512,1,1) lds=139264
.amdgcn_target "amdgcn-amd-amdhsa--gfx950"
.text
.globl recurrent_scan__mha_block_cached__geglu_ffn__decode_kernel
.p2align 8
.type recurrent_scan__mha_block_cached__geglu_ffn__decode_kernel,@function
recurrent_scan__mha_block_cached__geglu_ffn__decode_kernel:
    s_cmp_ge_u32 s2, 256
    s_cbranch_scc1 L_end
    s_load_dwordx16 s[40:55], s[0:1], 0
    s_load_dwordx8 s[56:63], s[0:1], 64
    v_lshrrev_b32 v1, 6, v0
    v_and_b32 v0, 63, v0
    v_readfirstlane_b32 s26, v1
    s_and_b32 s31, s2, 7
    s_lshr_b32 s32, s2, 3
    s_lshr_b32 s27, s32, 2
    s_and_b32 s33, s32, 1
    s_lshl_b32 s28, s31, 1
    s_or_b32 s28, s28, s33
    s_bfe_u32 s29, s32, 0x10001
    s_lshr_b32 s25, s32, 1
    s_mul_i32 s30, s31, 14
    s_add_u32 s30, s30, s25
    s_lshl_b32 s31, s28, 1
    s_add_u32 s31, s31, s29
    s_mov_b32 s22, 0x1000000
    s_mov_b32 s23, 0x20000
    s_cmp_ge_u32 s26, 4
    s_cbranch_scc1 L_helper

    s_lshl_b32 s33, s27, 4
    s_add_u32 s33, s33, s28
    s_lshl_b32 s33, s33, 21
    s_lshl_b32 s34, s29, 15
    s_add_u32 s33, s33, s34
    s_and_b32 s34, s26, 1
    s_lshl_b32 s34, s34, 10
    s_add_u32 s33, s33, s34
    s_lshr_b32 s34, s26, 1
    s_lshl_b32 s34, s34, 11
    s_add_u32 s33, s33, s34
    v_and_b32 v1, 31, v0
    v_lshl_add_u32 v1, v1, 4, s33
    v_lshrrev_b32 v2, 5, v0
    v_lshl_add_u32 v1, v2, 9, v1
    s_mov_b32 s24, 0
    s_mov_b32 s30, 0
    s_waitcnt lgkmcnt(0)
    s_mov_b32 s20, s62
    s_mov_b32 s21, s63
    s_mov_b32 s4, s42
    s_mov_b32 s5, s43
    s_mov_b32 s6, 0x10000000
    s_mov_b32 s7, 0x20000
    s_mov_b32 s8, s44
    s_mov_b32 s9, s45
    s_mov_b32 s10, 0x10000000
    s_mov_b32 s11, 0x20000
    s_mov_b32 s8, s42
    s_mov_b32 s9, s43
    s_mov_b32 s30, 0x40000
    buffer_load_dwordx4 v[64:67], v1, s[4:7], s24 offen offset:0 nt
    s_add_u32 s34, s24, 4096
    buffer_load_dwordx4 v[68:71], v1, s[4:7], s34 offen offset:0 nt
    s_add_u32 s34, s24, 8192
    buffer_load_dwordx4 v[72:75], v1, s[4:7], s34 offen offset:0 nt
    s_add_u32 s34, s24, 12288
    buffer_load_dwordx4 v[76:79], v1, s[4:7], s34 offen offset:0 nt
    s_add_u32 s34, s24, 16384
    buffer_load_dwordx4 v[80:83], v1, s[4:7], s34 offen offset:0 nt
    s_lshl_b32 s34, s26, 8
    v_lshl_add_u32 v50, v0, 2, s34
    v_mov_b32 v51, 15
    ds_write_b32 v50, v51 offset:1024
    s_waitcnt lgkmcnt(0)
    s_barrier
    v_and_b32 v40, 15, v0
    v_lshrrev_b32 v41, 4, v0
    v_lshrrev_b32 v42, 3, v40
    v_and_b32 v41, 1, v41
    v_and_b32 v43, 1, v0
    v_mov_b32 v44, 0xffff
    v_lshlrev_b32 v43, 4, v43
    v_lshlrev_b32 v44, v43, v44
    v_cmp_eq_u32 vcc, v41, v42
    v_bfe_u32 v45, v0, 1, 2
    s_nop 0
    v_cndmask_b32 v44, 0, v44, vcc
    v_cmp_eq_u32 vcc, 0, v45
    s_nop 1
    v_cndmask_b32 v6, 0, v44, vcc
    v_cmp_eq_u32 vcc, 1, v45
    s_nop 1
    v_cndmask_b32 v7, 0, v44, vcc
    v_cmp_eq_u32 vcc, 2, v45
    s_nop 1
    v_cndmask_b32 v8, 0, v44, vcc
    v_cmp_eq_u32 vcc, 3, v45
    s_nop 1
    v_cndmask_b32 v9, 0, v44, vcc
    v_mov_b32 v10, 0
    v_mov_b32 v11, 0
    v_mov_b32 v12, 0
    v_mov_b32 v13, 0
    v_mov_b32 v14, 0
    v_mov_b32 v48, 0xff7fffff
    s_mov_b32 s36, 0xcccccccc
    s_mov_b32 s37, 0xcccccccc
    s_mov_b32 s38, 0xaaaaaaaa
    s_mov_b32 s39, 0xaaaaaaaa
    s_mov_b32 s64, 0x3db8aa3b
    v_and_b32 v40, 31, v0
    v_lshlrev_b32 v40, 4, v40
    s_waitcnt vmcnt(4)
    s_add_u32 s34, s24, 20480
    buffer_load_dwordx4 v[84:87], v1, s[4:7], s34 offen offset:0 nt
    s_waitcnt vmcnt(4)
    s_add_u32 s34, s24, 24576
    buffer_load_dwordx4 v[88:91], v1, s[4:7], s34 offen offset:0 nt
    s_waitcnt vmcnt(4)
    s_add_u32 s34, s24, 28672
    buffer_load_dwordx4 v[92:95], v1, s[4:7], s34 offen offset:0 nt
    s_waitcnt vmcnt(4)
    s_add_u32 s34, s24, 131072
    buffer_load_dwordx4 v[96:99], v1, s[4:7], s34 offen offset:0 nt
    s_waitcnt vmcnt(4)
    s_add_u32 s34, s24, 135168
    buffer_load_dwordx4 v[100:103], v1, s[4:7], s34 offen offset:0 nt
    s_waitcnt vmcnt(4)
    s_add_u32 s34, s24, 139264
    buffer_load_dwordx4 v[104:107], v1, s[4:7], s34 offen offset:0 nt
    s_waitcnt vmcnt(4)
    s_add_u32 s34, s24, 143360
    buffer_load_dwordx4 v[108:111], v1, s[4:7], s34 offen offset:0 nt
    s_waitcnt vmcnt(4)
    s_add_u32 s34, s24, 147456
    buffer_load_dwordx4 v[112:115], v1, s[4:7], s34 offen offset:0 nt
    s_waitcnt vmcnt(4)
    s_add_u32 s34, s24, 151552
    buffer_load_dwordx4 v[116:119], v1, s[4:7], s34 offen offset:0 nt
    s_waitcnt vmcnt(4)
    s_add_u32 s34, s24, 155648
    buffer_load_dwordx4 v[120:123], v1, s[4:7], s34 offen offset:0 nt
    s_waitcnt vmcnt(4)
    s_add_u32 s34, s24, 159744
    buffer_load_dwordx4 v[124:127], v1, s[4:7], s34 offen offset:0 nt
    s_or_b32 s24, s24, 0x6ffff
    s_add_u32 s24, s24, 1
    s_bitcmp1_b32 s24, 21
    s_cselect_b32 s4, s44, s4
    s_cselect_b32 s5, s45, s5
    s_and_b32 s24, s24, 0x190000
    s_waitcnt vmcnt(4)
    buffer_load_dwordx4 v[128:131], v1, s[8:11], s30 offen offset:0 nt
    s_waitcnt vmcnt(4)
    s_add_u32 s34, s30, 4096
    buffer_load_dwordx4 v[132:135], v1, s[8:11], s34 offen offset:0 nt
    s_waitcnt vmcnt(4)
    s_add_u32 s34, s30, 8192
    buffer_load_dwordx4 v[136:139], v1, s[8:11], s34 offen offset:0 nt
    s_waitcnt vmcnt(4)
    s_add_u32 s34, s30, 12288
    buffer_load_dwordx4 v[140:143], v1, s[8:11], s34 offen offset:0 nt
    s_waitcnt vmcnt(4)
    s_add_u32 s34, s30, 16384
    buffer_load_dwordx4 v[144:147], v1, s[8:11], s34 offen offset:0 nt
    s_waitcnt vmcnt(4)
    s_add_u32 s34, s30, 20480
    buffer_load_dwordx4 v[148:151], v1, s[8:11], s34 offen offset:0 nt
    s_waitcnt vmcnt(4)
    s_add_u32 s34, s30, 24576
    buffer_load_dwordx4 v[152:155], v1, s[8:11], s34 offen offset:0 nt
    s_waitcnt vmcnt(4)
    s_add_u32 s34, s30, 28672
    buffer_load_dwordx4 v[156:159], v1, s[8:11], s34 offen offset:0 nt
    s_waitcnt vmcnt(4)
    s_add_u32 s34, s30, 131072
    buffer_load_dwordx4 v[160:163], v1, s[8:11], s34 offen offset:0 nt
    s_waitcnt vmcnt(4)
    s_add_u32 s34, s30, 135168
    buffer_load_dwordx4 v[164:167], v1, s[8:11], s34 offen offset:0 nt
    s_waitcnt vmcnt(4)
    s_add_u32 s34, s30, 139264
    buffer_load_dwordx4 v[168:171], v1, s[8:11], s34 offen offset:0 nt
    s_waitcnt vmcnt(4)
    s_add_u32 s34, s30, 143360
    buffer_load_dwordx4 v[172:175], v1, s[8:11], s34 offen offset:0 nt
    s_waitcnt vmcnt(4)
    s_add_u32 s34, s30, 147456
    buffer_load_dwordx4 v[176:179], v1, s[8:11], s34 offen offset:0 nt
    s_waitcnt vmcnt(4)
    s_add_u32 s34, s30, 151552
    buffer_load_dwordx4 v[180:183], v1, s[8:11], s34 offen offset:0 nt
    s_waitcnt vmcnt(4)
    s_add_u32 s34, s30, 155648
    buffer_load_dwordx4 v[184:187], v1, s[8:11], s34 offen offset:0 nt
    s_waitcnt vmcnt(4)
    s_add_u32 s34, s30, 159744
    buffer_load_dwordx4 v[188:191], v1, s[8:11], s34 offen offset:0 nt
    s_or_b32 s30, s30, 0x6ffff
    s_add_u32 s30, s30, 1
    s_bitcmp1_b32 s30, 21
    s_cselect_b32 s8, s44, s8
    s_cselect_b32 s9, s45, s9
    s_and_b32 s30, s30, 0x190000
    s_or_b32 s30, s30, 0x40000
    s_waitcnt vmcnt(4)
    buffer_load_dwordx4 v[192:195], v1, s[4:7], s24 offen offset:0 nt
    s_waitcnt vmcnt(4)
    s_add_u32 s34, s24, 4096
    buffer_load_dwordx4 v[196:199], v1, s[4:7], s34 offen offset:0 nt
    s_waitcnt vmcnt(4)
    s_add_u32 s34, s24, 8192
    buffer_load_dwordx4 v[200:203], v1, s[4:7], s34 offen offset:0 nt
    s_waitcnt vmcnt(4)
    s_add_u32 s34, s24, 12288
    buffer_load_dwordx4 v[204:207], v1, s[4:7], s34 offen offset:0 nt
    s_waitcnt vmcnt(4)
    s_add_u32 s34, s24, 16384
    buffer_load_dwordx4 v[208:211], v1, s[4:7], s34 offen offset:0 nt
    s_waitcnt vmcnt(4)
    s_add_u32 s34, s24, 20480
    buffer_load_dwordx4 v[212:215], v1, s[4:7], s34 offen offset:0 nt
    s_waitcnt vmcnt(4)
    s_add_u32 s34, s24, 24576
    buffer_load_dwordx4 v[216:219], v1, s[4:7], s34 offen offset:0 nt
    s_waitcnt vmcnt(4)
    s_add_u32 s34, s24, 28672
    buffer_load_dwordx4 v[220:223], v1, s[4:7], s34 offen offset:0 nt
    s_waitcnt vmcnt(4)
    s_add_u32 s34, s24, 131072
    buffer_load_dwordx4 v[224:227], v1, s[4:7], s34 offen offset:0 nt
    s_waitcnt vmcnt(4)
    s_add_u32 s34, s24, 135168
    buffer_load_dwordx4 v[228:231], v1, s[4:7], s34 offen offset:0 nt
    s_waitcnt vmcnt(4)
    s_add_u32 s34, s24, 139264
    buffer_load_dwordx4 v[232:235], v1, s[4:7], s34 offen offset:0 nt
    s_waitcnt vmcnt(4)
    s_add_u32 s34, s24, 143360
    buffer_load_dwordx4 v[236:239], v1, s[4:7], s34 offen offset:0 nt
    s_waitcnt vmcnt(4)
    s_add_u32 s34, s24, 147456
    buffer_load_dwordx4 v[240:243], v1, s[4:7], s34 offen offset:0 nt
    s_waitcnt vmcnt(4)
    s_add_u32 s34, s24, 151552
    buffer_load_dwordx4 v[244:247], v1, s[4:7], s34 offen offset:0 nt
    s_waitcnt vmcnt(4)
    s_add_u32 s34, s24, 155648
    buffer_load_dwordx4 v[248:251], v1, s[4:7], s34 offen offset:0 nt
    s_waitcnt vmcnt(4)
    s_add_u32 s34, s24, 159744
    buffer_load_dwordx4 v[252:255], v1, s[4:7], s34 offen offset:0 nt
    s_or_b32 s24, s24, 0x6ffff
    s_add_u32 s24, s24, 1
    s_bitcmp1_b32 s24, 21
    s_cselect_b32 s4, s44, s4
    s_cselect_b32 s5, s45, s5
    s_and_b32 s24, s24, 0x190000
    s_barrier
    v_mov_b32 v53, 8260
    ds_read_b32 v53, v53
    s_and_b32 s72, s32, 7
    s_lshl_b32 s69, s72, 12
    s_mov_b32 s69, 2154496
    s_and_b32 s70, s32, 24
    s_and_b32 s71, s2, 7
    s_add_u32 s70, s70, s71
    s_lshl_b32 s70, s70, 7
    s_lshl_b32 s71, s26, 30
    s_cmp_lg_u32 s72, 5
    s_cselect_b32 s71, 0x40000000, s71
    s_add_u32 s70, s70, s71
    v_lshrrev_b32 v55, 5, v0
    v_lshl_add_u32 v54, v55, 24, s70
    v_lshl_add_u32 v54, v0, 2, v54
    v_lshrrev_b32 v55, 5, v0
    v_lshlrev_b32 v55, 24, v55
    v_lshl_add_u32 v55, v0, 7, v55
    s_mov_b32 s68, 0
    v_mov_b32 v56, 0
    v_mov_b32 v58, 0
    s_mov_b32 s78, 0
    ds_read_b128 v[2:5], v40 offset:0
    s_waitcnt lgkmcnt(0)
    v_readfirstlane_b32 s65, v53
    s_and_b32 s65, s65, 0x3ff
    s_waitcnt vmcnt(47)
    v_dot2_f32_bf16 v16, v64, v2, 0
    v_dot2_f32_bf16 v16, v65, v3, v16
    v_dot2_f32_bf16 v16, v66, v4, v16
    v_dot2_f32_bf16 v16, v67, v5, v16
    s_waitcnt vmcnt(46)
    v_dot2_f32_bf16 v17, v68, v2, 0
    v_dot2_f32_bf16 v17, v69, v3, v17
    v_dot2_f32_bf16 v17, v70, v4, v17
    v_dot2_f32_bf16 v17, v71, v5, v17
    s_waitcnt vmcnt(45)
    v_dot2_f32_bf16 v18, v72, v2, 0
    v_dot2_f32_bf16 v18, v73, v3, v18
    v_dot2_f32_bf16 v18, v74, v4, v18
    v_dot2_f32_bf16 v18, v75, v5, v18
    s_waitcnt vmcnt(44)
    v_dot2_f32_bf16 v19, v76, v2, 0
    v_dot2_f32_bf16 v19, v77, v3, v19
    v_dot2_f32_bf16 v19, v78, v4, v19
    v_dot2_f32_bf16 v19, v79, v5, v19
    s_waitcnt vmcnt(43)
    v_dot2_f32_bf16 v20, v80, v2, 0
    v_dot2_f32_bf16 v20, v81, v3, v20
    v_dot2_f32_bf16 v20, v82, v4, v20
    v_dot2_f32_bf16 v20, v83, v5, v20
    s_waitcnt vmcnt(42)
    v_dot2_f32_bf16 v21, v84, v2, 0
    v_dot2_f32_bf16 v21, v85, v3, v21
    v_dot2_f32_bf16 v21, v86, v4, v21
    v_dot2_f32_bf16 v21, v87, v5, v21
    s_waitcnt vmcnt(41)
    v_dot2_f32_bf16 v22, v88, v2, 0
    v_dot2_f32_bf16 v22, v89, v3, v22
    v_dot2_f32_bf16 v22, v90, v4, v22
    v_dot2_f32_bf16 v22, v91, v5, v22
    s_waitcnt vmcnt(40)
    v_dot2_f32_bf16 v23, v92, v2, 0
    v_dot2_f32_bf16 v23, v93, v3, v23
    v_dot2_f32_bf16 v23, v94, v4, v23
    v_dot2_f32_bf16 v23, v95, v5, v23
    s_waitcnt vmcnt(39)
    v_dot2_f32_bf16 v24, v96, v2, 0
    v_dot2_f32_bf16 v24, v97, v3, v24
    v_dot2_f32_bf16 v24, v98, v4, v24
    v_dot2_f32_bf16 v24, v99, v5, v24
    s_waitcnt vmcnt(38)
    v_dot2_f32_bf16 v25, v100, v2, 0
    v_dot2_f32_bf16 v25, v101, v3, v25
    v_dot2_f32_bf16 v25, v102, v4, v25
    v_dot2_f32_bf16 v25, v103, v5, v25
    s_waitcnt vmcnt(37)
    v_dot2_f32_bf16 v26, v104, v2, 0
    v_dot2_f32_bf16 v26, v105, v3, v26
    v_dot2_f32_bf16 v26, v106, v4, v26
    v_dot2_f32_bf16 v26, v107, v5, v26
    s_waitcnt vmcnt(36)
    v_dot2_f32_bf16 v27, v108, v2, 0
    v_dot2_f32_bf16 v27, v109, v3, v27
    v_dot2_f32_bf16 v27, v110, v4, v27
    v_dot2_f32_bf16 v27, v111, v5, v27
    s_waitcnt vmcnt(35)
    v_dot2_f32_bf16 v28, v112, v2, 0
    v_dot2_f32_bf16 v28, v113, v3, v28
    v_dot2_f32_bf16 v28, v114, v4, v28
    v_dot2_f32_bf16 v28, v115, v5, v28
    s_waitcnt vmcnt(34)
    v_dot2_f32_bf16 v29, v116, v2, 0
    v_dot2_f32_bf16 v29, v117, v3, v29
    v_dot2_f32_bf16 v29, v118, v4, v29
    v_dot2_f32_bf16 v29, v119, v5, v29
    s_waitcnt vmcnt(33)
    v_dot2_f32_bf16 v30, v120, v2, 0
    v_dot2_f32_bf16 v30, v121, v3, v30
    v_dot2_f32_bf16 v30, v122, v4, v30
    v_dot2_f32_bf16 v30, v123, v5, v30
    s_waitcnt vmcnt(32)
    v_dot2_f32_bf16 v31, v124, v2, 0
    v_dot2_f32_bf16 v31, v125, v3, v31
    v_dot2_f32_bf16 v31, v126, v4, v31
    v_dot2_f32_bf16 v31, v127, v5, v31
    v_add_f32_dpp v16, v16, v16 row_ror:8 row_mask:0xf bank_mask:0x3
    v_add_f32_dpp v17, v17, v17 row_ror:8 row_mask:0xf bank_mask:0x3
    v_add_f32_dpp v18, v18, v18 row_ror:8 row_mask:0xf bank_mask:0x3
    v_add_f32_dpp v19, v19, v19 row_ror:8 row_mask:0xf bank_mask:0x3
    v_add_f32_dpp v20, v20, v20 row_ror:8 row_mask:0xf bank_mask:0x3
    v_add_f32_dpp v21, v21, v21 row_ror:8 row_mask:0xf bank_mask:0x3
    v_add_f32_dpp v22, v22, v22 row_ror:8 row_mask:0xf bank_mask:0x3
    v_add_f32_dpp v23, v23, v23 row_ror:8 row_mask:0xf bank_mask:0x3
    v_add_f32_dpp v16, v24, v24 row_ror:8 row_mask:0xf bank_mask:0xc
    v_add_f32_dpp v17, v25, v25 row_ror:8 row_mask:0xf bank_mask:0xc
    v_add_f32_dpp v18, v26, v26 row_ror:8 row_mask:0xf bank_mask:0xc
    v_add_f32_dpp v19, v27, v27 row_ror:8 row_mask:0xf bank_mask:0xc
    v_add_f32_dpp v20, v28, v28 row_ror:8 row_mask:0xf bank_mask:0xc
    v_add_f32_dpp v21, v29, v29 row_ror:8 row_mask:0xf bank_mask:0xc
    v_add_f32_dpp v22, v30, v30 row_ror:8 row_mask:0xf bank_mask:0xc
    v_add_f32_dpp v23, v31, v31 row_ror:8 row_mask:0xf bank_mask:0xc
    v_add_f32_dpp v16, v16, v16 row_half_mirror row_mask:0xf bank_mask:0x5
    v_add_f32_dpp v17, v17, v17 row_half_mirror row_mask:0xf bank_mask:0x5
    v_add_f32_dpp v18, v18, v18 row_half_mirror row_mask:0xf bank_mask:0x5
    v_add_f32_dpp v19, v19, v19 row_half_mirror row_mask:0xf bank_mask:0x5
    v_add_f32_dpp v16, v20, v20 row_half_mirror row_mask:0xf bank_mask:0xa
    v_add_f32_dpp v17, v21, v21 row_half_mirror row_mask:0xf bank_mask:0xa
    v_add_f32_dpp v18, v22, v22 row_half_mirror row_mask:0xf bank_mask:0xa
    v_add_f32_dpp v19, v23, v23 row_half_mirror row_mask:0xf bank_mask:0xa
    v_add_f32_dpp v20, v16, v16 quad_perm:[2,3,0,1] row_mask:0xf bank_mask:0xf
    v_add_f32_dpp v21, v17, v17 quad_perm:[2,3,0,1] row_mask:0xf bank_mask:0xf
    v_add_f32_dpp v22, v18, v18 quad_perm:[2,3,0,1] row_mask:0xf bank_mask:0xf
    v_add_f32_dpp v23, v19, v19 quad_perm:[2,3,0,1] row_mask:0xf bank_mask:0xf
    v_cndmask_b32 v16, v20, v22, s[36:37]
    v_cndmask_b32 v17, v21, v23, s[36:37]
    s_nop 0
    v_add_f32_dpp v18, v16, v16 quad_perm:[1,0,3,2] row_mask:0xf bank_mask:0xf
    v_add_f32_dpp v19, v17, v17 quad_perm:[1,0,3,2] row_mask:0xf bank_mask:0xf
    v_cndmask_b32 v16, v18, v19, s[38:39]
    v_cndmask_b32 v17, v18, v19, s[38:39]
    s_nop 1
    v_permlane16_swap_b32 v16, v17
    v_add_f32 v16, v16, v17
    v_cvt_pk_bf16_f32 v16, v16, v16
    v_and_b32 v16, 0xffff0000, v16
    v_max_f32 v48, v16, v48
    v_mov_b32 v32, v16
    s_waitcnt vmcnt(31)
    v_dot2_f32_bf16 v16, v128, v2, 0
    v_dot2_f32_bf16 v16, v129, v3, v16
    v_dot2_f32_bf16 v16, v130, v4, v16
    v_dot2_f32_bf16 v16, v131, v5, v16
    s_waitcnt vmcnt(5)
    buffer_load_dwordx4 v[128:131], v1, s[8:11], s30 offen offset:0 nt
    v_dot2_f32_bf16 v17, v132, v2, 0
    v_dot2_f32_bf16 v17, v133, v3, v17
    v_dot2_f32_bf16 v17, v134, v4, v17
    v_dot2_f32_bf16 v17, v135, v5, v17
    s_waitcnt vmcnt(5)
    s_add_u32 s34, s30, 4096
    buffer_load_dwordx4 v[132:135], v1, s[8:11], s34 offen offset:0 nt
    v_dot2_f32_bf16 v18, v136, v2, 0
    v_dot2_f32_bf16 v18, v137, v3, v18
    v_dot2_f32_bf16 v18, v138, v4, v18
    v_dot2_f32_bf16 v18, v139, v5, v18
    s_waitcnt vmcnt(5)
    s_add_u32 s34, s30, 8192
    buffer_load_dwordx4 v[136:139], v1, s[8:11], s34 offen offset:0 nt
    v_dot2_f32_bf16 v19, v140, v2, 0
    v_dot2_f32_bf16 v19, v141, v3, v19
    v_dot2_f32_bf16 v19, v142, v4, v19
    v_dot2_f32_bf16 v19, v143, v5, v19
    s_waitcnt vmcnt(5)
    s_add_u32 s34, s30, 12288
    buffer_load_dwordx4 v[140:143], v1, s[8:11], s34 offen offset:0 nt
    v_dot2_f32_bf16 v20, v144, v2, 0
    v_dot2_f32_bf16 v20, v145, v3, v20
    v_dot2_f32_bf16 v20, v146, v4, v20
    v_dot2_f32_bf16 v20, v147, v5, v20
    s_waitcnt vmcnt(5)
    s_add_u32 s34, s30, 16384
    buffer_load_dwordx4 v[144:147], v1, s[8:11], s34 offen offset:0 nt
    v_dot2_f32_bf16 v21, v148, v2, 0
    v_dot2_f32_bf16 v21, v149, v3, v21
    v_dot2_f32_bf16 v21, v150, v4, v21
    v_dot2_f32_bf16 v21, v151, v5, v21
    s_waitcnt vmcnt(5)
    s_add_u32 s34, s30, 20480
    buffer_load_dwordx4 v[148:151], v1, s[8:11], s34 offen offset:0 nt
    v_dot2_f32_bf16 v22, v152, v2, 0
    v_dot2_f32_bf16 v22, v153, v3, v22
    v_dot2_f32_bf16 v22, v154, v4, v22
    v_dot2_f32_bf16 v22, v155, v5, v22
    s_waitcnt vmcnt(5)
    s_add_u32 s34, s30, 24576
    buffer_load_dwordx4 v[152:155], v1, s[8:11], s34 offen offset:0 nt
    v_dot2_f32_bf16 v23, v156, v2, 0
    v_dot2_f32_bf16 v23, v157, v3, v23
    v_dot2_f32_bf16 v23, v158, v4, v23
    v_dot2_f32_bf16 v23, v159, v5, v23
    v_dot2_f32_bf16 v24, v160, v2, 0
    v_dot2_f32_bf16 v24, v161, v3, v24
    v_dot2_f32_bf16 v24, v162, v4, v24
    v_dot2_f32_bf16 v24, v163, v5, v24
    v_dot2_f32_bf16 v25, v164, v2, 0
    v_dot2_f32_bf16 v25, v165, v3, v25
    v_dot2_f32_bf16 v25, v166, v4, v25
    v_dot2_f32_bf16 v25, v167, v5, v25
    v_dot2_f32_bf16 v26, v168, v2, 0
    v_dot2_f32_bf16 v26, v169, v3, v26
    v_dot2_f32_bf16 v26, v170, v4, v26
    v_dot2_f32_bf16 v26, v171, v5, v26
    v_dot2_f32_bf16 v27, v172, v2, 0
    v_dot2_f32_bf16 v27, v173, v3, v27
    v_dot2_f32_bf16 v27, v174, v4, v27
    v_dot2_f32_bf16 v27, v175, v5, v27
    v_dot2_f32_bf16 v28, v176, v2, 0
    v_dot2_f32_bf16 v28, v177, v3, v28
    v_dot2_f32_bf16 v28, v178, v4, v28
    v_dot2_f32_bf16 v28, v179, v5, v28
    v_dot2_f32_bf16 v29, v180, v2, 0
    v_dot2_f32_bf16 v29, v181, v3, v29
    v_dot2_f32_bf16 v29, v182, v4, v29
    v_dot2_f32_bf16 v29, v183, v5, v29
    v_dot2_f32_bf16 v30, v184, v2, 0
    v_dot2_f32_bf16 v30, v185, v3, v30
    v_dot2_f32_bf16 v30, v186, v4, v30
    v_dot2_f32_bf16 v30, v187, v5, v30
    v_dot2_f32_bf16 v31, v188, v2, 0
    v_dot2_f32_bf16 v31, v189, v3, v31
    v_dot2_f32_bf16 v31, v190, v4, v31
    v_dot2_f32_bf16 v31, v191, v5, v31
    v_add_f32_dpp v16, v16, v16 row_ror:8 row_mask:0xf bank_mask:0x3
    v_add_f32_dpp v17, v17, v17 row_ror:8 row_mask:0xf bank_mask:0x3
    v_add_f32_dpp v18, v18, v18 row_ror:8 row_mask:0xf bank_mask:0x3
    v_add_f32_dpp v19, v19, v19 row_ror:8 row_mask:0xf bank_mask:0x3
    v_add_f32_dpp v20, v20, v20 row_ror:8 row_mask:0xf bank_mask:0x3
    v_add_f32_dpp v21, v21, v21 row_ror:8 row_mask:0xf bank_mask:0x3
    v_add_f32_dpp v22, v22, v22 row_ror:8 row_mask:0xf bank_mask:0x3
    v_add_f32_dpp v23, v23, v23 row_ror:8 row_mask:0xf bank_mask:0x3
    v_add_f32_dpp v16, v24, v24 row_ror:8 row_mask:0xf bank_mask:0xc
    v_add_f32_dpp v17, v25, v25 row_ror:8 row_mask:0xf bank_mask:0xc
    v_add_f32_dpp v18, v26, v26 row_ror:8 row_mask:0xf bank_mask:0xc
    v_add_f32_dpp v19, v27, v27 row_ror:8 row_mask:0xf bank_mask:0xc
    v_add_f32_dpp v20, v28, v28 row_ror:8 row_mask:0xf bank_mask:0xc
    v_add_f32_dpp v21, v29, v29 row_ror:8 row_mask:0xf bank_mask:0xc
    v_add_f32_dpp v22, v30, v30 row_ror:8 row_mask:0xf bank_mask:0xc
    v_add_f32_dpp v23, v31, v31 row_ror:8 row_mask:0xf bank_mask:0xc
    v_add_f32_dpp v16, v16, v16 row_half_mirror row_mask:0xf bank_mask:0x5
    v_add_f32_dpp v17, v17, v17 row_half_mirror row_mask:0xf bank_mask:0x5
    v_add_f32_dpp v18, v18, v18 row_half_mirror row_mask:0xf bank_mask:0x5
    v_add_f32_dpp v19, v19, v19 row_half_mirror row_mask:0xf bank_mask:0x5
    v_add_f32_dpp v16, v20, v20 row_half_mirror row_mask:0xf bank_mask:0xa
    v_add_f32_dpp v17, v21, v21 row_half_mirror row_mask:0xf bank_mask:0xa
    v_add_f32_dpp v18, v22, v22 row_half_mirror row_mask:0xf bank_mask:0xa
    v_add_f32_dpp v19, v23, v23 row_half_mirror row_mask:0xf bank_mask:0xa
    v_add_f32_dpp v20, v16, v16 quad_perm:[2,3,0,1] row_mask:0xf bank_mask:0xf
    v_add_f32_dpp v21, v17, v17 quad_perm:[2,3,0,1] row_mask:0xf bank_mask:0xf
    v_add_f32_dpp v22, v18, v18 quad_perm:[2,3,0,1] row_mask:0xf bank_mask:0xf
    v_add_f32_dpp v23, v19, v19 quad_perm:[2,3,0,1] row_mask:0xf bank_mask:0xf
    v_cndmask_b32 v16, v20, v22, s[36:37]
    v_cndmask_b32 v17, v21, v23, s[36:37]
    s_nop 0
    v_add_f32_dpp v18, v16, v16 quad_perm:[1,0,3,2] row_mask:0xf bank_mask:0xf
    v_add_f32_dpp v19, v17, v17 quad_perm:[1,0,3,2] row_mask:0xf bank_mask:0xf
    v_cndmask_b32 v16, v18, v19, s[38:39]
    v_cndmask_b32 v17, v18, v19, s[38:39]
    s_nop 1
    v_permlane16_swap_b32 v16, v17
    v_add_f32 v16, v16, v17
    v_cvt_pk_bf16_f32 v16, v16, v16
    v_and_b32 v16, 0xffff0000, v16
    v_max_f32 v48, v16, v48
    v_mov_b32 v33, v16
    v_dot2_f32_bf16 v16, v192, v2, 0
    v_dot2_f32_bf16 v16, v193, v3, v16
    v_dot2_f32_bf16 v16, v194, v4, v16
    v_dot2_f32_bf16 v16, v195, v5, v16
    v_dot2_f32_bf16 v17, v196, v2, 0
    v_dot2_f32_bf16 v17, v197, v3, v17
    v_dot2_f32_bf16 v17, v198, v4, v17
    v_dot2_f32_bf16 v17, v199, v5, v17
    v_dot2_f32_bf16 v18, v200, v2, 0
    v_dot2_f32_bf16 v18, v201, v3, v18
    v_dot2_f32_bf16 v18, v202, v4, v18
    v_dot2_f32_bf16 v18, v203, v5, v18
    v_dot2_f32_bf16 v19, v204, v2, 0
    v_dot2_f32_bf16 v19, v205, v3, v19
    v_dot2_f32_bf16 v19, v206, v4, v19
    v_dot2_f32_bf16 v19, v207, v5, v19
    v_dot2_f32_bf16 v20, v208, v2, 0
    v_dot2_f32_bf16 v20, v209, v3, v20
    v_dot2_f32_bf16 v20, v210, v4, v20
    v_dot2_f32_bf16 v20, v211, v5, v20
    v_dot2_f32_bf16 v21, v212, v2, 0
    v_dot2_f32_bf16 v21, v213, v3, v21
    v_dot2_f32_bf16 v21, v214, v4, v21
    v_dot2_f32_bf16 v21, v215, v5, v21
    v_dot2_f32_bf16 v22, v216, v2, 0
    v_dot2_f32_bf16 v22, v217, v3, v22
    v_dot2_f32_bf16 v22, v218, v4, v22
    v_dot2_f32_bf16 v22, v219, v5, v22
    v_dot2_f32_bf16 v23, v220, v2, 0
    v_dot2_f32_bf16 v23, v221, v3, v23
    v_dot2_f32_bf16 v23, v222, v4, v23
    v_dot2_f32_bf16 v23, v223, v5, v23
    v_dot2_f32_bf16 v24, v224, v2, 0
    v_dot2_f32_bf16 v24, v225, v3, v24
    v_dot2_f32_bf16 v24, v226, v4, v24
    v_dot2_f32_bf16 v24, v227, v5, v24
    v_dot2_f32_bf16 v25, v228, v2, 0
    v_dot2_f32_bf16 v25, v229, v3, v25
    v_dot2_f32_bf16 v25, v230, v4, v25
    v_dot2_f32_bf16 v25, v231, v5, v25
    v_dot2_f32_bf16 v26, v232, v2, 0
    v_dot2_f32_bf16 v26, v233, v3, v26
    v_dot2_f32_bf16 v26, v234, v4, v26
    v_dot2_f32_bf16 v26, v235, v5, v26
    v_dot2_f32_bf16 v27, v236, v2, 0
    v_dot2_f32_bf16 v27, v237, v3, v27
    v_dot2_f32_bf16 v27, v238, v4, v27
    v_dot2_f32_bf16 v27, v239, v5, v27
    v_dot2_f32_bf16 v28, v240, v2, 0
    v_dot2_f32_bf16 v28, v241, v3, v28
    v_dot2_f32_bf16 v28, v242, v4, v28
    v_dot2_f32_bf16 v28, v243, v5, v28
    v_dot2_f32_bf16 v29, v244, v2, 0
    v_dot2_f32_bf16 v29, v245, v3, v29
    v_dot2_f32_bf16 v29, v246, v4, v29
    v_dot2_f32_bf16 v29, v247, v5, v29
    v_dot2_f32_bf16 v30, v248, v2, 0
    v_dot2_f32_bf16 v30, v249, v3, v30
    v_dot2_f32_bf16 v30, v250, v4, v30
    v_dot2_f32_bf16 v30, v251, v5, v30
    v_dot2_f32_bf16 v31, v252, v2, 0
    v_dot2_f32_bf16 v31, v253, v3, v31
    v_dot2_f32_bf16 v31, v254, v4, v31
    v_dot2_f32_bf16 v31, v255, v5, v31
    v_add_f32_dpp v16, v16, v16 row_ror:8 row_mask:0xf bank_mask:0x3
    v_add_f32_dpp v17, v17, v17 row_ror:8 row_mask:0xf bank_mask:0x3
    v_add_f32_dpp v18, v18, v18 row_ror:8 row_mask:0xf bank_mask:0x3
    v_add_f32_dpp v19, v19, v19 row_ror:8 row_mask:0xf bank_mask:0x3
    v_add_f32_dpp v20, v20, v20 row_ror:8 row_mask:0xf bank_mask:0x3
    v_add_f32_dpp v21, v21, v21 row_ror:8 row_mask:0xf bank_mask:0x3
    v_add_f32_dpp v22, v22, v22 row_ror:8 row_mask:0xf bank_mask:0x3
    v_add_f32_dpp v23, v23, v23 row_ror:8 row_mask:0xf bank_mask:0x3
    v_add_f32_dpp v16, v24, v24 row_ror:8 row_mask:0xf bank_mask:0xc
    v_add_f32_dpp v17, v25, v25 row_ror:8 row_mask:0xf bank_mask:0xc
    v_add_f32_dpp v18, v26, v26 row_ror:8 row_mask:0xf bank_mask:0xc
    v_add_f32_dpp v19, v27, v27 row_ror:8 row_mask:0xf bank_mask:0xc
    v_add_f32_dpp v20, v28, v28 row_ror:8 row_mask:0xf bank_mask:0xc
    v_add_f32_dpp v21, v29, v29 row_ror:8 row_mask:0xf bank_mask:0xc
    v_add_f32_dpp v22, v30, v30 row_ror:8 row_mask:0xf bank_mask:0xc
    v_add_f32_dpp v23, v31, v31 row_ror:8 row_mask:0xf bank_mask:0xc
    v_add_f32_dpp v16, v16, v16 row_half_mirror row_mask:0xf bank_mask:0x5
    v_add_f32_dpp v17, v17, v17 row_half_mirror row_mask:0xf bank_mask:0x5
    v_add_f32_dpp v18, v18, v18 row_half_mirror row_mask:0xf bank_mask:0x5
    v_add_f32_dpp v19, v19, v19 row_half_mirror row_mask:0xf bank_mask:0x5
    v_add_f32_dpp v16, v20, v20 row_half_mirror row_mask:0xf bank_mask:0xa
    v_add_f32_dpp v17, v21, v21 row_half_mirror row_mask:0xf bank_mask:0xa
    v_add_f32_dpp v18, v22, v22 row_half_mirror row_mask:0xf bank_mask:0xa
    v_add_f32_dpp v19, v23, v23 row_half_mirror row_mask:0xf bank_mask:0xa
    v_add_f32_dpp v20, v16, v16 quad_perm:[2,3,0,1] row_mask:0xf bank_mask:0xf
    v_add_f32_dpp v21, v17, v17 quad_perm:[2,3,0,1] row_mask:0xf bank_mask:0xf
    v_add_f32_dpp v22, v18, v18 quad_perm:[2,3,0,1] row_mask:0xf bank_mask:0xf
    v_add_f32_dpp v23, v19, v19 quad_perm:[2,3,0,1] row_mask:0xf bank_mask:0xf
    v_cndmask_b32 v16, v20, v22, s[36:37]
    v_cndmask_b32 v17, v21, v23, s[36:37]
    s_nop 0
    v_add_f32_dpp v18, v16, v16 quad_perm:[1,0,3,2] row_mask:0xf bank_mask:0xf
    v_add_f32_dpp v19, v17, v17 quad_perm:[1,0,3,2] row_mask:0xf bank_mask:0xf
    v_cndmask_b32 v16, v18, v19, s[38:39]
    v_cndmask_b32 v17, v18, v19, s[38:39]
    s_nop 1
    v_permlane16_swap_b32 v16, v17
    v_add_f32 v16, v16, v17
    v_cvt_pk_bf16_f32 v16, v16, v16
    v_and_b32 v16, 0xffff0000, v16
    v_max_f32 v48, v16, v48
    v_mov_b32 v204, v32
    v_mov_b32 v205, v33
    v_mov_b32 v206, v16
    s_waitcnt vmcnt(5)
    s_add_u32 s34, s30, 28672
    buffer_load_dwordx4 v[156:159], v1, s[8:11], s34 offen offset:0 nt
    v_dot2_f32_bf16 v16, v128, v2, 0
    v_dot2_f32_bf16 v16, v129, v3, v16
    v_dot2_f32_bf16 v16, v130, v4, v16
    v_dot2_f32_bf16 v16, v131, v5, v16
    s_waitcnt vmcnt(5)
    s_add_u32 s34, s30, 131072
    buffer_load_dwordx4 v[160:163], v1, s[8:11], s34 offen offset:0 nt
    v_dot2_f32_bf16 v17, v132, v2, 0
    v_dot2_f32_bf16 v17, v133, v3, v17
    v_dot2_f32_bf16 v17, v134, v4, v17
    v_dot2_f32_bf16 v17, v135, v5, v17
    s_waitcnt vmcnt(5)
    s_add_u32 s34, s30, 135168
    buffer_load_dwordx4 v[164:167], v1, s[8:11], s34 offen offset:0 nt
    v_dot2_f32_bf16 v18, v136, v2, 0
    v_dot2_f32_bf16 v18, v137, v3, v18
    v_dot2_f32_bf16 v18, v138, v4, v18
    v_dot2_f32_bf16 v18, v139, v5, v18
    s_waitcnt vmcnt(5)
    s_add_u32 s34, s30, 139264
    buffer_load_dwordx4 v[168:171], v1, s[8:11], s34 offen offset:0 nt
    v_dot2_f32_bf16 v19, v140, v2, 0
    v_dot2_f32_bf16 v19, v141, v3, v19
    v_dot2_f32_bf16 v19, v142, v4, v19
    v_dot2_f32_bf16 v19, v143, v5, v19
    s_waitcnt vmcnt(5)
    s_add_u32 s34, s30, 143360
    buffer_load_dwordx4 v[172:175], v1, s[8:11], s34 offen offset:0 nt
    v_dot2_f32_bf16 v20, v144, v2, 0
    v_dot2_f32_bf16 v20, v145, v3, v20
    v_dot2_f32_bf16 v20, v146, v4, v20
    v_dot2_f32_bf16 v20, v147, v5, v20
    s_waitcnt vmcnt(5)
    s_add_u32 s34, s30, 147456
    buffer_load_dwordx4 v[176:179], v1, s[8:11], s34 offen offset:0 nt
    v_dot2_f32_bf16 v21, v148, v2, 0
    v_dot2_f32_bf16 v21, v149, v3, v21
    v_dot2_f32_bf16 v21, v150, v4, v21
    v_dot2_f32_bf16 v21, v151, v5, v21
    s_waitcnt vmcnt(5)
    s_add_u32 s34, s30, 151552
    buffer_load_dwordx4 v[180:183], v1, s[8:11], s34 offen offset:0 nt
    v_dot2_f32_bf16 v22, v152, v2, 0
    v_dot2_f32_bf16 v22, v153, v3, v22
    v_dot2_f32_bf16 v22, v154, v4, v22
    v_dot2_f32_bf16 v22, v155, v5, v22
    s_waitcnt vmcnt(5)
    s_add_u32 s34, s30, 155648
    buffer_load_dwordx4 v[184:187], v1, s[8:11], s34 offen offset:0 nt
    v_dot2_f32_bf16 v23, v156, v2, 0
    v_dot2_f32_bf16 v23, v157, v3, v23
    v_dot2_f32_bf16 v23, v158, v4, v23
    v_dot2_f32_bf16 v23, v159, v5, v23
    s_waitcnt vmcnt(5)
    s_add_u32 s34, s30, 159744
    buffer_load_dwordx4 v[188:191], v1, s[8:11], s34 offen offset:0 nt
    s_or_b32 s30, s30, 0x6ffff
    s_add_u32 s30, s30, 1
    s_bitcmp1_b32 s30, 21
    s_cselect_b32 s8, s44, s8
    s_cselect_b32 s9, s45, s9
    s_and_b32 s30, s30, 0x190000
    s_or_b32 s30, s30, 0x40000
    v_dot2_f32_bf16 v24, v160, v2, 0
    v_dot2_f32_bf16 v24, v161, v3, v24
    v_dot2_f32_bf16 v24, v162, v4, v24
    v_dot2_f32_bf16 v24, v163, v5, v24
    s_waitcnt vmcnt(5)
    buffer_load_dwordx4 v[64:67], v1, s[4:7], s24 offen offset:0 nt
    v_dot2_f32_bf16 v25, v164, v2, 0
    v_dot2_f32_bf16 v25, v165, v3, v25
    v_dot2_f32_bf16 v25, v166, v4, v25
    v_dot2_f32_bf16 v25, v167, v5, v25
    s_waitcnt vmcnt(5)
    s_add_u32 s34, s24, 4096
    buffer_load_dwordx4 v[68:71], v1, s[4:7], s34 offen offset:0 nt
    v_dot2_f32_bf16 v26, v168, v2, 0
    v_dot2_f32_bf16 v26, v169, v3, v26
    v_dot2_f32_bf16 v26, v170, v4, v26
    v_dot2_f32_bf16 v26, v171, v5, v26
    s_waitcnt vmcnt(5)
    s_add_u32 s34, s24, 8192
    buffer_load_dwordx4 v[72:75], v1, s[4:7], s34 offen offset:0 nt
    v_dot2_f32_bf16 v27, v172, v2, 0
    v_dot2_f32_bf16 v27, v173, v3, v27
    v_dot2_f32_bf16 v27, v174, v4, v27
    v_dot2_f32_bf16 v27, v175, v5, v27
    s_waitcnt vmcnt(5)
    s_add_u32 s34, s24, 12288
    buffer_load_dwordx4 v[76:79], v1, s[4:7], s34 offen offset:0 nt
    v_dot2_f32_bf16 v28, v176, v2, 0
    v_dot2_f32_bf16 v28, v177, v3, v28
    v_dot2_f32_bf16 v28, v178, v4, v28
    v_dot2_f32_bf16 v28, v179, v5, v28
    s_waitcnt vmcnt(5)
    s_add_u32 s34, s24, 16384
    buffer_load_dwordx4 v[80:83], v1, s[4:7], s34 offen offset:0 nt
    v_dot2_f32_bf16 v29, v180, v2, 0
    v_dot2_f32_bf16 v29, v181, v3, v29
    v_dot2_f32_bf16 v29, v182, v4, v29
    v_dot2_f32_bf16 v29, v183, v5, v29
    s_waitcnt vmcnt(5)
    s_add_u32 s34, s24, 20480
    buffer_load_dwordx4 v[84:87], v1, s[4:7], s34 offen offset:0 nt
    v_dot2_f32_bf16 v30, v184, v2, 0
    v_dot2_f32_bf16 v30, v185, v3, v30
    v_dot2_f32_bf16 v30, v186, v4, v30
    v_dot2_f32_bf16 v30, v187, v5, v30
    s_waitcnt vmcnt(5)
    s_add_u32 s34, s24, 24576
    buffer_load_dwordx4 v[88:91], v1, s[4:7], s34 offen offset:0 nt
    v_dot2_f32_bf16 v31, v188, v2, 0
    v_dot2_f32_bf16 v31, v189, v3, v31
    v_dot2_f32_bf16 v31, v190, v4, v31
    v_dot2_f32_bf16 v31, v191, v5, v31
    v_add_f32_dpp v16, v16, v16 row_ror:8 row_mask:0xf bank_mask:0x3
    v_add_f32_dpp v17, v17, v17 row_ror:8 row_mask:0xf bank_mask:0x3
    v_add_f32_dpp v18, v18, v18 row_ror:8 row_mask:0xf bank_mask:0x3
    v_add_f32_dpp v19, v19, v19 row_ror:8 row_mask:0xf bank_mask:0x3
    v_add_f32_dpp v20, v20, v20 row_ror:8 row_mask:0xf bank_mask:0x3
    v_add_f32_dpp v21, v21, v21 row_ror:8 row_mask:0xf bank_mask:0x3
    v_add_f32_dpp v22, v22, v22 row_ror:8 row_mask:0xf bank_mask:0x3
    v_add_f32_dpp v23, v23, v23 row_ror:8 row_mask:0xf bank_mask:0x3
    v_add_f32_dpp v16, v24, v24 row_ror:8 row_mask:0xf bank_mask:0xc
    v_add_f32_dpp v17, v25, v25 row_ror:8 row_mask:0xf bank_mask:0xc
    v_add_f32_dpp v18, v26, v26 row_ror:8 row_mask:0xf bank_mask:0xc
    v_add_f32_dpp v19, v27, v27 row_ror:8 row_mask:0xf bank_mask:0xc
    v_add_f32_dpp v20, v28, v28 row_ror:8 row_mask:0xf bank_mask:0xc
    v_add_f32_dpp v21, v29, v29 row_ror:8 row_mask:0xf bank_mask:0xc
    v_add_f32_dpp v22, v30, v30 row_ror:8 row_mask:0xf bank_mask:0xc
    v_add_f32_dpp v23, v31, v31 row_ror:8 row_mask:0xf bank_mask:0xc
    v_add_f32_dpp v16, v16, v16 row_half_mirror row_mask:0xf bank_mask:0x5
    v_add_f32_dpp v17, v17, v17 row_half_mirror row_mask:0xf bank_mask:0x5
    v_add_f32_dpp v18, v18, v18 row_half_mirror row_mask:0xf bank_mask:0x5
    v_add_f32_dpp v19, v19, v19 row_half_mirror row_mask:0xf bank_mask:0x5
    v_add_f32_dpp v16, v20, v20 row_half_mirror row_mask:0xf bank_mask:0xa
    v_add_f32_dpp v17, v21, v21 row_half_mirror row_mask:0xf bank_mask:0xa
    v_add_f32_dpp v18, v22, v22 row_half_mirror row_mask:0xf bank_mask:0xa
    v_add_f32_dpp v19, v23, v23 row_half_mirror row_mask:0xf bank_mask:0xa
    v_add_f32_dpp v20, v16, v16 quad_perm:[2,3,0,1] row_mask:0xf bank_mask:0xf
    v_add_f32_dpp v21, v17, v17 quad_perm:[2,3,0,1] row_mask:0xf bank_mask:0xf
    v_add_f32_dpp v22, v18, v18 quad_perm:[2,3,0,1] row_mask:0xf bank_mask:0xf
    v_add_f32_dpp v23, v19, v19 quad_perm:[2,3,0,1] row_mask:0xf bank_mask:0xf
    v_cndmask_b32 v16, v20, v22, s[36:37]
    v_cndmask_b32 v17, v21, v23, s[36:37]
    s_nop 0
    v_add_f32_dpp v18, v16, v16 quad_perm:[1,0,3,2] row_mask:0xf bank_mask:0xf
    v_add_f32_dpp v19, v17, v17 quad_perm:[1,0,3,2] row_mask:0xf bank_mask:0xf
    v_cndmask_b32 v16, v18, v19, s[38:39]
    v_cndmask_b32 v17, v18, v19, s[38:39]
    s_nop 1
    v_permlane16_swap_b32 v16, v17
    v_add_f32 v16, v16, v17
    v_cvt_pk_bf16_f32 v16, v16, v16
    v_and_b32 v16, 0xffff0000, v16
    v_max_f32 v48, v16, v48
    v_mov_b32 v207, v16
    s_mov_b32 s33, 13
L_loop:
    v_mov_b32 v51, s33
    ds_write_b32 v50, v51 offset:1024
    s_memrealtime s[66:67]
    s_cmp_eq_u32 s78, 1
    s_cbranch_scc1 L_u1
    s_cmp_eq_u32 s78, 2
    s_cbranch_scc1 L_u2
L_u0:
    s_waitcnt vmcnt(5)
    s_add_u32 s34, s24, 28672
    buffer_load_dwordx4 v[92:95], v1, s[4:7], s34 offen offset:0 nt
    v_dot2_f32_bf16 v16, v64, v2, 0
    v_dot2_f32_bf16 v16, v65, v3, v16
    v_dot2_f32_bf16 v16, v66, v4, v16
    v_dot2_f32_bf16 v16, v67, v5, v16
    s_waitcnt vmcnt(5)
    s_add_u32 s34, s24, 131072
    buffer_load_dwordx4 v[96:99], v1, s[4:7], s34 offen offset:0 nt
    v_dot2_f32_bf16 v17, v68, v2, 0
    v_dot2_f32_bf16 v17, v69, v3, v17
    v_dot2_f32_bf16 v17, v70, v4, v17
    v_dot2_f32_bf16 v17, v71, v5, v17
    s_waitcnt vmcnt(5)
    s_add_u32 s34, s24, 135168
    buffer_load_dwordx4 v[100:103], v1, s[4:7], s34 offen offset:0 nt
    s_waitcnt lgkmcnt(0)
    s_mov_b32 s79, s68
    s_lshl_b32 s68, s66, 10
    s_or_b32 s68, s68, s65
    s_mov_b32 s77, s69
    s_sub_u32 s69, s69, 4096
    v_mov_b32 v53, s68
    buffer_store_dword v53, v54, s[20:23], s69 offen sc1
    v_dot2_f32_bf16 v18, v72, v2, 0
    v_dot2_f32_bf16 v18, v73, v3, v18
    v_dot2_f32_bf16 v18, v74, v4, v18
    v_dot2_f32_bf16 v18, v75, v5, v18
    s_waitcnt vmcnt(5)
    s_add_u32 s34, s24, 139264
    buffer_load_dwordx4 v[104:107], v1, s[4:7], s34 offen offset:0 nt
    v_dot2_f32_bf16 v19, v76, v2, 0
    v_dot2_f32_bf16 v19, v77, v3, v19
    v_dot2_f32_bf16 v19, v78, v4, v19
    v_dot2_f32_bf16 v19, v79, v5, v19
    s_waitcnt vmcnt(5)
    s_add_u32 s34, s24, 143360
    buffer_load_dwordx4 v[108:111], v1, s[4:7], s34 offen offset:0 nt
    v_dot2_f32_bf16 v20, v80, v2, 0
    v_dot2_f32_bf16 v20, v81, v3, v20
    v_dot2_f32_bf16 v20, v82, v4, v20
    v_dot2_f32_bf16 v20, v83, v5, v20
    s_waitcnt vmcnt(5)
    s_add_u32 s34, s24, 147456
    buffer_load_dwordx4 v[112:115], v1, s[4:7], s34 offen offset:0 nt
    v_dot2_f32_bf16 v21, v84, v2, 0
    v_dot2_f32_bf16 v21, v85, v3, v21
    v_dot2_f32_bf16 v21, v86, v4, v21
    v_dot2_f32_bf16 v21, v87, v5, v21
    s_waitcnt vmcnt(5)
    s_add_u32 s34, s24, 151552
    buffer_load_dwordx4 v[116:119], v1, s[4:7], s34 offen offset:0 nt
    v_dot2_f32_bf16 v22, v88, v2, 0
    v_dot2_f32_bf16 v22, v89, v3, v22
    v_dot2_f32_bf16 v22, v90, v4, v22
    v_dot2_f32_bf16 v22, v91, v5, v22
    s_waitcnt vmcnt(5)
    s_add_u32 s34, s24, 155648
    buffer_load_dwordx4 v[120:123], v1, s[4:7], s34 offen offset:0 nt
    v_dot2_f32_bf16 v23, v92, v2, 0
    v_dot2_f32_bf16 v23, v93, v3, v23
    v_dot2_f32_bf16 v23, v94, v4, v23
    v_dot2_f32_bf16 v23, v95, v5, v23
    s_waitcnt vmcnt(5)
    s_add_u32 s34, s24, 159744
    buffer_load_dwordx4 v[124:127], v1, s[4:7], s34 offen offset:0 nt
    s_or_b32 s24, s24, 0x6ffff
    s_add_u32 s24, s24, 1
    s_bitcmp1_b32 s24, 21
    s_cselect_b32 s4, s44, s4
    s_cselect_b32 s5, s45, s5
    s_and_b32 s24, s24, 0x190000
    v_dot2_f32_bf16 v24, v96, v2, 0
    v_dot2_f32_bf16 v24, v97, v3, v24
    v_dot2_f32_bf16 v24, v98, v4, v24
    v_dot2_f32_bf16 v24, v99, v5, v24
    s_waitcnt vmcnt(5)
    buffer_load_dwordx4 v[128:131], v1, s[8:11], s30 offen offset:0 nt
    v_dot2_f32_bf16 v25, v100, v2, 0
    v_dot2_f32_bf16 v25, v101, v3, v25
    v_dot2_f32_bf16 v25, v102, v4, v25
    v_dot2_f32_bf16 v25, v103, v5, v25
    s_waitcnt vmcnt(5)
    s_add_u32 s34, s30, 4096
    buffer_load_dwordx4 v[132:135], v1, s[8:11], s34 offen offset:0 nt
    v_dot2_f32_bf16 v26, v104, v2, 0
    v_dot2_f32_bf16 v26, v105, v3, v26
    v_dot2_f32_bf16 v26, v106, v4, v26
    v_dot2_f32_bf16 v26, v107, v5, v26
    s_waitcnt vmcnt(5)
    s_add_u32 s34, s30, 8192
    buffer_load_dwordx4 v[136:139], v1, s[8:11], s34 offen offset:0 nt
    buffer_load_dword v56, v55, s[20:23], s77 offen
    v_dot2_f32_bf16 v27, v108, v2, 0
    v_dot2_f32_bf16 v27, v109, v3, v27
    v_dot2_f32_bf16 v27, v110, v4, v27
    v_dot2_f32_bf16 v27, v111, v5, v27
    s_waitcnt vmcnt(5)
    s_add_u32 s34, s30, 12288
    buffer_load_dwordx4 v[140:143], v1, s[8:11], s34 offen offset:0 nt
    v_dot2_f32_bf16 v28, v112, v2, 0
    v_dot2_f32_bf16 v28, v113, v3, v28
    v_dot2_f32_bf16 v28, v114, v4, v28
    v_dot2_f32_bf16 v28, v115, v5, v28
    s_waitcnt vmcnt(5)
    s_add_u32 s34, s30, 16384
    buffer_load_dwordx4 v[144:147], v1, s[8:11], s34 offen offset:0 nt
    v_dot2_f32_bf16 v29, v116, v2, 0
    v_dot2_f32_bf16 v29, v117, v3, v29
    v_dot2_f32_bf16 v29, v118, v4, v29
    v_dot2_f32_bf16 v29, v119, v5, v29
    s_waitcnt vmcnt(5)
    s_add_u32 s34, s30, 20480
    buffer_load_dwordx4 v[148:151], v1, s[8:11], s34 offen offset:0 nt
    v_dot2_f32_bf16 v30, v120, v2, 0
    v_dot2_f32_bf16 v30, v121, v3, v30
    v_dot2_f32_bf16 v30, v122, v4, v30
    v_dot2_f32_bf16 v30, v123, v5, v30
    s_waitcnt vmcnt(5)
    s_add_u32 s34, s30, 24576
    buffer_load_dwordx4 v[152:155], v1, s[8:11], s34 offen offset:0 nt
    v_dot2_f32_bf16 v31, v124, v2, 0
    v_dot2_f32_bf16 v31, v125, v3, v31
    v_dot2_f32_bf16 v31, v126, v4, v31
    v_dot2_f32_bf16 v31, v127, v5, v31
    v_add_f32_dpp v16, v16, v16 row_ror:8 row_mask:0xf bank_mask:0x3
    v_add_f32_dpp v17, v17, v17 row_ror:8 row_mask:0xf bank_mask:0x3
    v_add_f32_dpp v18, v18, v18 row_ror:8 row_mask:0xf bank_mask:0x3
    v_add_f32_dpp v19, v19, v19 row_ror:8 row_mask:0xf bank_mask:0x3
    v_add_f32_dpp v20, v20, v20 row_ror:8 row_mask:0xf bank_mask:0x3
    v_add_f32_dpp v21, v21, v21 row_ror:8 row_mask:0xf bank_mask:0x3
    v_add_f32_dpp v22, v22, v22 row_ror:8 row_mask:0xf bank_mask:0x3
    v_add_f32_dpp v23, v23, v23 row_ror:8 row_mask:0xf bank_mask:0x3
    v_add_f32_dpp v16, v24, v24 row_ror:8 row_mask:0xf bank_mask:0xc
    v_add_f32_dpp v17, v25, v25 row_ror:8 row_mask:0xf bank_mask:0xc
    v_add_f32_dpp v18, v26, v26 row_ror:8 row_mask:0xf bank_mask:0xc
    v_add_f32_dpp v19, v27, v27 row_ror:8 row_mask:0xf bank_mask:0xc
    v_add_f32_dpp v20, v28, v28 row_ror:8 row_mask:0xf bank_mask:0xc
    v_add_f32_dpp v21, v29, v29 row_ror:8 row_mask:0xf bank_mask:0xc
    v_add_f32_dpp v22, v30, v30 row_ror:8 row_mask:0xf bank_mask:0xc
    v_add_f32_dpp v23, v31, v31 row_ror:8 row_mask:0xf bank_mask:0xc
    v_add_f32_dpp v16, v16, v16 row_half_mirror row_mask:0xf bank_mask:0x5
    v_add_f32_dpp v17, v17, v17 row_half_mirror row_mask:0xf bank_mask:0x5
    v_add_f32_dpp v18, v18, v18 row_half_mirror row_mask:0xf bank_mask:0x5
    v_add_f32_dpp v19, v19, v19 row_half_mirror row_mask:0xf bank_mask:0x5
    v_add_f32_dpp v16, v20, v20 row_half_mirror row_mask:0xf bank_mask:0xa
    v_add_f32_dpp v17, v21, v21 row_half_mirror row_mask:0xf bank_mask:0xa
    v_add_f32_dpp v18, v22, v22 row_half_mirror row_mask:0xf bank_mask:0xa
    v_add_f32_dpp v19, v23, v23 row_half_mirror row_mask:0xf bank_mask:0xa
    v_add_f32_dpp v20, v16, v16 quad_perm:[2,3,0,1] row_mask:0xf bank_mask:0xf
    v_add_f32_dpp v21, v17, v17 quad_perm:[2,3,0,1] row_mask:0xf bank_mask:0xf
    v_add_f32_dpp v22, v18, v18 quad_perm:[2,3,0,1] row_mask:0xf bank_mask:0xf
    v_add_f32_dpp v23, v19, v19 quad_perm:[2,3,0,1] row_mask:0xf bank_mask:0xf
    v_cndmask_b32 v16, v20, v22, s[36:37]
    v_cndmask_b32 v17, v21, v23, s[36:37]
    s_nop 0
    v_add_f32_dpp v18, v16, v16 quad_perm:[1,0,3,2] row_mask:0xf bank_mask:0xf
    v_add_f32_dpp v19, v17, v17 quad_perm:[1,0,3,2] row_mask:0xf bank_mask:0xf
    v_cndmask_b32 v16, v18, v19, s[38:39]
    v_cndmask_b32 v17, v18, v19, s[38:39]
    s_nop 1
    v_permlane16_swap_b32 v16, v17
    v_add_f32 v16, v16, v17
    v_cvt_pk_bf16_f32 v16, v16, v16
    v_and_b32 v16, 0xffff0000, v16
    v_max_f32 v48, v16, v48
    v_mov_b32 v192, v194
    v_mov_b32 v193, v195
    v_mov_b32 v194, v196
    v_mov_b32 v195, v197
    v_mov_b32 v196, v198
    v_mov_b32 v197, v199
    v_mov_b32 v198, v200
    v_mov_b32 v199, v201
    v_mov_b32 v200, v202
    v_mov_b32 v201, v203
    v_mov_b32 v202, v204
    v_mov_b32 v203, v205
    v_mov_b32 v204, v206
    v_mov_b32 v205, v207
    v_mov_b32 v206, v16
    s_waitcnt vmcnt(5)
    s_add_u32 s34, s30, 28672
    buffer_load_dwordx4 v[156:159], v1, s[8:11], s34 offen offset:0 nt
    v_dot2_f32_bf16 v16, v128, v2, 0
    v_dot2_f32_bf16 v16, v129, v3, v16
    v_dot2_f32_bf16 v16, v130, v4, v16
    v_dot2_f32_bf16 v16, v131, v5, v16
    s_waitcnt vmcnt(5)
    s_add_u32 s34, s30, 131072
    buffer_load_dwordx4 v[160:163], v1, s[8:11], s34 offen offset:0 nt
    v_dot2_f32_bf16 v17, v132, v2, 0
    v_dot2_f32_bf16 v17, v133, v3, v17
    v_dot2_f32_bf16 v17, v134, v4, v17
    v_dot2_f32_bf16 v17, v135, v5, v17
    s_waitcnt vmcnt(5)
    s_add_u32 s34, s30, 135168
    buffer_load_dwordx4 v[164:167], v1, s[8:11], s34 offen offset:0 nt
    v_dot2_f32_bf16 v18, v136, v2, 0
    v_dot2_f32_bf16 v18, v137, v3, v18
    v_dot2_f32_bf16 v18, v138, v4, v18
    v_dot2_f32_bf16 v18, v139, v5, v18
    s_waitcnt vmcnt(5)
    s_add_u32 s34, s30, 139264
    buffer_load_dwordx4 v[168:171], v1, s[8:11], s34 offen offset:0 nt
    v_dot2_f32_bf16 v19, v140, v2, 0
    v_dot2_f32_bf16 v19, v141, v3, v19
    v_dot2_f32_bf16 v19, v142, v4, v19
    v_dot2_f32_bf16 v19, v143, v5, v19
    s_waitcnt vmcnt(5)
    s_add_u32 s34, s30, 143360
    buffer_load_dwordx4 v[172:175], v1, s[8:11], s34 offen offset:0 nt
    v_dot2_f32_bf16 v20, v144, v2, 0
    v_dot2_f32_bf16 v20, v145, v3, v20
    v_dot2_f32_bf16 v20, v146, v4, v20
    v_dot2_f32_bf16 v20, v147, v5, v20
    s_waitcnt vmcnt(5)
    s_add_u32 s34, s30, 147456
    buffer_load_dwordx4 v[176:179], v1, s[8:11], s34 offen offset:0 nt
    v_dot2_f32_bf16 v21, v148, v2, 0
    v_dot2_f32_bf16 v21, v149, v3, v21
    v_dot2_f32_bf16 v21, v150, v4, v21
    v_dot2_f32_bf16 v21, v151, v5, v21
    s_waitcnt vmcnt(5)
    s_add_u32 s34, s30, 151552
    buffer_load_dwordx4 v[180:183], v1, s[8:11], s34 offen offset:0 nt
    v_dot2_f32_bf16 v22, v152, v2, 0
    v_dot2_f32_bf16 v22, v153, v3, v22
    v_dot2_f32_bf16 v22, v154, v4, v22
    v_dot2_f32_bf16 v22, v155, v5, v22
    s_waitcnt vmcnt(5)
    s_add_u32 s34, s30, 155648
    buffer_load_dwordx4 v[184:187], v1, s[8:11], s34 offen offset:0 nt
    v_dot2_f32_bf16 v23, v156, v2, 0
    v_dot2_f32_bf16 v23, v157, v3, v23
    v_dot2_f32_bf16 v23, v158, v4, v23
    v_dot2_f32_bf16 v23, v159, v5, v23
    s_waitcnt vmcnt(5)
    s_add_u32 s34, s30, 159744
    buffer_load_dwordx4 v[188:191], v1, s[8:11], s34 offen offset:0 nt
    s_or_b32 s30, s30, 0x6ffff
    s_add_u32 s30, s30, 1
    s_bitcmp1_b32 s30, 21
    s_cselect_b32 s8, s44, s8
    s_cselect_b32 s9, s45, s9
    s_and_b32 s30, s30, 0x190000
    s_or_b32 s30, s30, 0x40000
    v_dot2_f32_bf16 v24, v160, v2, 0
    v_dot2_f32_bf16 v24, v161, v3, v24
    v_dot2_f32_bf16 v24, v162, v4, v24
    v_dot2_f32_bf16 v24, v163, v5, v24
    s_waitcnt vmcnt(5)
    buffer_load_dwordx4 v[64:67], v1, s[4:7], s24 offen offset:0 nt
    v_dot2_f32_bf16 v25, v164, v2, 0
    v_dot2_f32_bf16 v25, v165, v3, v25
    v_dot2_f32_bf16 v25, v166, v4, v25
    v_dot2_f32_bf16 v25, v167, v5, v25
    s_waitcnt vmcnt(5)
    s_add_u32 s34, s24, 4096
    buffer_load_dwordx4 v[68:71], v1, s[4:7], s34 offen offset:0 nt
    v_dot2_f32_bf16 v26, v168, v2, 0
    v_dot2_f32_bf16 v26, v169, v3, v26
    v_dot2_f32_bf16 v26, v170, v4, v26
    v_dot2_f32_bf16 v26, v171, v5, v26
    s_waitcnt vmcnt(5)
    s_add_u32 s34, s24, 8192
    buffer_load_dwordx4 v[72:75], v1, s[4:7], s34 offen offset:0 nt
    v_dot2_f32_bf16 v27, v172, v2, 0
    v_dot2_f32_bf16 v27, v173, v3, v27
    v_dot2_f32_bf16 v27, v174, v4, v27
    v_dot2_f32_bf16 v27, v175, v5, v27
    s_waitcnt vmcnt(5)
    s_add_u32 s34, s24, 12288
    buffer_load_dwordx4 v[76:79], v1, s[4:7], s34 offen offset:0 nt
    v_dot2_f32_bf16 v28, v176, v2, 0
    v_dot2_f32_bf16 v28, v177, v3, v28
    v_dot2_f32_bf16 v28, v178, v4, v28
    v_dot2_f32_bf16 v28, v179, v5, v28
    s_waitcnt vmcnt(5)
    s_add_u32 s34, s24, 16384
    buffer_load_dwordx4 v[80:83], v1, s[4:7], s34 offen offset:0 nt
    v_sub_u32 v57, v56, v58
    v_mov_b32 v58, v56
    v_add_u32 v56, v56, v57
    v_subrev_u32 v56, s68, v56
    v_and_b32 v57, 0x3ff, v56
    v_cmp_eq_u32 s[70:71], 0, v57
    v_cmp_gt_i32 vcc, 0xffff6000, v56
    s_and_b32 s72, vcc_lo, s70
    v_cmp_lt_i32 vcc, 0xf000, v56
    s_bcnt1_i32_b32 s72, s72
    s_orn2_b32 s73, vcc_lo, s70
    s_bcnt1_i32_b32 s73, s73
    s_cmp_gt_u32 s73, 16
    s_cselect_b32 s78, 1, 0
    s_cmp_ge_u32 s72, 16
    s_cselect_b32 s78, 2, s78
    s_cmp_ge_u32 s33, 12
    s_cselect_b32 s78, 0, s78
    v_dot2_f32_bf16 v29, v180, v2, 0
    v_dot2_f32_bf16 v29, v181, v3, v29
    v_dot2_f32_bf16 v29, v182, v4, v29
    v_dot2_f32_bf16 v29, v183, v5, v29
    s_waitcnt vmcnt(5)
    s_add_u32 s34, s24, 20480
    buffer_load_dwordx4 v[84:87], v1, s[4:7], s34 offen offset:0 nt
    v_dot2_f32_bf16 v30, v184, v2, 0
    v_dot2_f32_bf16 v30, v185, v3, v30
    v_dot2_f32_bf16 v30, v186, v4, v30
    v_dot2_f32_bf16 v30, v187, v5, v30
    s_waitcnt vmcnt(5)
    s_add_u32 s34, s24, 24576
    buffer_load_dwordx4 v[88:91], v1, s[4:7], s34 offen offset:0 nt
    v_dot2_f32_bf16 v31, v188, v2, 0
    v_dot2_f32_bf16 v31, v189, v3, v31
    v_dot2_f32_bf16 v31, v190, v4, v31
    v_dot2_f32_bf16 v31, v191, v5, v31
    v_add_f32_dpp v16, v16, v16 row_ror:8 row_mask:0xf bank_mask:0x3
    v_add_f32_dpp v17, v17, v17 row_ror:8 row_mask:0xf bank_mask:0x3
    v_add_f32_dpp v18, v18, v18 row_ror:8 row_mask:0xf bank_mask:0x3
    v_add_f32_dpp v19, v19, v19 row_ror:8 row_mask:0xf bank_mask:0x3
    v_add_f32_dpp v20, v20, v20 row_ror:8 row_mask:0xf bank_mask:0x3
    v_add_f32_dpp v21, v21, v21 row_ror:8 row_mask:0xf bank_mask:0x3
    v_add_f32_dpp v22, v22, v22 row_ror:8 row_mask:0xf bank_mask:0x3
    v_add_f32_dpp v23, v23, v23 row_ror:8 row_mask:0xf bank_mask:0x3
    v_add_f32_dpp v16, v24, v24 row_ror:8 row_mask:0xf bank_mask:0xc
    v_add_f32_dpp v17, v25, v25 row_ror:8 row_mask:0xf bank_mask:0xc
    v_add_f32_dpp v18, v26, v26 row_ror:8 row_mask:0xf bank_mask:0xc
    v_add_f32_dpp v19, v27, v27 row_ror:8 row_mask:0xf bank_mask:0xc
    v_add_f32_dpp v20, v28, v28 row_ror:8 row_mask:0xf bank_mask:0xc
    v_add_f32_dpp v21, v29, v29 row_ror:8 row_mask:0xf bank_mask:0xc
    v_add_f32_dpp v22, v30, v30 row_ror:8 row_mask:0xf bank_mask:0xc
    v_add_f32_dpp v23, v31, v31 row_ror:8 row_mask:0xf bank_mask:0xc
    v_add_f32_dpp v16, v16, v16 row_half_mirror row_mask:0xf bank_mask:0x5
    v_add_f32_dpp v17, v17, v17 row_half_mirror row_mask:0xf bank_mask:0x5
    v_add_f32_dpp v18, v18, v18 row_half_mirror row_mask:0xf bank_mask:0x5
    v_add_f32_dpp v19, v19, v19 row_half_mirror row_mask:0xf bank_mask:0x5
    v_add_f32_dpp v16, v20, v20 row_half_mirror row_mask:0xf bank_mask:0xa
    v_add_f32_dpp v17, v21, v21 row_half_mirror row_mask:0xf bank_mask:0xa
    v_add_f32_dpp v18, v22, v22 row_half_mirror row_mask:0xf bank_mask:0xa
    v_add_f32_dpp v19, v23, v23 row_half_mirror row_mask:0xf bank_mask:0xa
    v_add_f32_dpp v20, v16, v16 quad_perm:[2,3,0,1] row_mask:0xf bank_mask:0xf
    v_add_f32_dpp v21, v17, v17 quad_perm:[2,3,0,1] row_mask:0xf bank_mask:0xf
    v_add_f32_dpp v22, v18, v18 quad_perm:[2,3,0,1] row_mask:0xf bank_mask:0xf
    v_add_f32_dpp v23, v19, v19 quad_perm:[2,3,0,1] row_mask:0xf bank_mask:0xf
    v_cndmask_b32 v16, v20, v22, s[36:37]
    v_cndmask_b32 v17, v21, v23, s[36:37]
    s_nop 0
    v_add_f32_dpp v18, v16, v16 quad_perm:[1,0,3,2] row_mask:0xf bank_mask:0xf
    v_add_f32_dpp v19, v17, v17 quad_perm:[1,0,3,2] row_mask:0xf bank_mask:0xf
    v_cndmask_b32 v16, v18, v19, s[38:39]
    v_cndmask_b32 v17, v18, v19, s[38:39]
    s_nop 1
    v_permlane16_swap_b32 v16, v17
    v_add_f32 v16, v16, v17
    v_cvt_pk_bf16_f32 v16, v16, v16
    v_and_b32 v16, 0xffff0000, v16
    v_max_f32 v48, v16, v48
    v_mov_b32 v207, v16
    s_sub_u32 s33, s33, 1
    s_cmp_lg_u32 s33, 7
    s_cbranch_scc1 L_loop
    s_branch L_soft
L_u1:
    s_waitcnt vmcnt(4)
    s_add_u32 s34, s24, 28672
    buffer_load_dwordx4 v[92:95], v1, s[4:7], s34 offen offset:0 nt
    v_dot2_f32_bf16 v16, v64, v2, 0
    v_dot2_f32_bf16 v16, v65, v3, v16
    v_dot2_f32_bf16 v16, v66, v4, v16
    v_dot2_f32_bf16 v16, v67, v5, v16
    s_waitcnt vmcnt(4)
    s_add_u32 s34, s24, 131072
    buffer_load_dwordx4 v[96:99], v1, s[4:7], s34 offen offset:0 nt
    v_dot2_f32_bf16 v17, v68, v2, 0
    v_dot2_f32_bf16 v17, v69, v3, v17
    v_dot2_f32_bf16 v17, v70, v4, v17
    v_dot2_f32_bf16 v17, v71, v5, v17
    s_waitcnt vmcnt(4)
    s_add_u32 s34, s24, 135168
    buffer_load_dwordx4 v[100:103], v1, s[4:7], s34 offen offset:0 nt
    s_waitcnt lgkmcnt(0)
    s_mov_b32 s79, s68
    s_lshl_b32 s68, s66, 10
    s_or_b32 s68, s68, s65
    s_mov_b32 s77, s69
    s_sub_u32 s69, s69, 4096
    v_mov_b32 v53, s68
    buffer_store_dword v53, v54, s[20:23], s69 offen sc1
    v_dot2_f32_bf16 v18, v72, v2, 0
    v_dot2_f32_bf16 v18, v73, v3, v18
    v_dot2_f32_bf16 v18, v74, v4, v18
    v_dot2_f32_bf16 v18, v75, v5, v18
    s_waitcnt vmcnt(4)
    s_add_u32 s34, s24, 139264
    buffer_load_dwordx4 v[104:107], v1, s[4:7], s34 offen offset:0 nt
    v_dot2_f32_bf16 v19, v76, v2, 0
    v_dot2_f32_bf16 v19, v77, v3, v19
    v_dot2_f32_bf16 v19, v78, v4, v19
    v_dot2_f32_bf16 v19, v79, v5, v19
    s_waitcnt vmcnt(4)
    s_add_u32 s34, s24, 143360
    buffer_load_dwordx4 v[108:111], v1, s[4:7], s34 offen offset:0 nt
    v_dot2_f32_bf16 v20, v80, v2, 0
    v_dot2_f32_bf16 v20, v81, v3, v20
    v_dot2_f32_bf16 v20, v82, v4, v20
    v_dot2_f32_bf16 v20, v83, v5, v20
    s_waitcnt vmcnt(4)
    s_add_u32 s34, s24, 147456
    buffer_load_dwordx4 v[112:115], v1, s[4:7], s34 offen offset:0 nt
    v_dot2_f32_bf16 v21, v84, v2, 0
    v_dot2_f32_bf16 v21, v85, v3, v21
    v_dot2_f32_bf16 v21, v86, v4, v21
    v_dot2_f32_bf16 v21, v87, v5, v21
    s_waitcnt vmcnt(4)
    s_add_u32 s34, s24, 151552
    buffer_load_dwordx4 v[116:119], v1, s[4:7], s34 offen offset:0 nt
    v_dot2_f32_bf16 v22, v88, v2, 0
    v_dot2_f32_bf16 v22, v89, v3, v22
    v_dot2_f32_bf16 v22, v90, v4, v22
    v_dot2_f32_bf16 v22, v91, v5, v22
    s_waitcnt vmcnt(4)
    s_add_u32 s34, s24, 155648
    buffer_load_dwordx4 v[120:123], v1, s[4:7], s34 offen offset:0 nt
    v_dot2_f32_bf16 v23, v92, v2, 0
    v_dot2_f32_bf16 v23, v93, v3, v23
    v_dot2_f32_bf16 v23, v94, v4, v23
    v_dot2_f32_bf16 v23, v95, v5, v23
    s_waitcnt vmcnt(4)
    s_add_u32 s34, s24, 159744
    buffer_load_dwordx4 v[124:127], v1, s[4:7], s34 offen offset:0 nt
    s_or_b32 s24, s24, 0x6ffff
    s_add_u32 s24, s24, 1
    s_bitcmp1_b32 s24, 21
    s_cselect_b32 s4, s44, s4
    s_cselect_b32 s5, s45, s5
    s_and_b32 s24, s24, 0x190000
    v_dot2_f32_bf16 v24, v96, v2, 0
    v_dot2_f32_bf16 v24, v97, v3, v24
    v_dot2_f32_bf16 v24, v98, v4, v24
    v_dot2_f32_bf16 v24, v99, v5, v24
    s_waitcnt vmcnt(4)
    buffer_load_dwordx4 v[128:131], v1, s[8:11], s30 offen offset:0 nt
    v_dot2_f32_bf16 v25, v100, v2, 0
    v_dot2_f32_bf16 v25, v101, v3, v25
    v_dot2_f32_bf16 v25, v102, v4, v25
    v_dot2_f32_bf16 v25, v103, v5, v25
    s_waitcnt vmcnt(4)
    s_add_u32 s34, s30, 4096
    buffer_load_dwordx4 v[132:135], v1, s[8:11], s34 offen offset:0 nt
    v_dot2_f32_bf16 v26, v104, v2, 0
    v_dot2_f32_bf16 v26, v105, v3, v26
    v_dot2_f32_bf16 v26, v106, v4, v26
    v_dot2_f32_bf16 v26, v107, v5, v26
    s_waitcnt vmcnt(4)
    s_add_u32 s34, s30, 8192
    buffer_load_dwordx4 v[136:139], v1, s[8:11], s34 offen offset:0 nt
    buffer_load_dword v56, v55, s[20:23], s77 offen
    v_dot2_f32_bf16 v27, v108, v2, 0
    v_dot2_f32_bf16 v27, v109, v3, v27
    v_dot2_f32_bf16 v27, v110, v4, v27
    v_dot2_f32_bf16 v27, v111, v5, v27
    s_waitcnt vmcnt(4)
    s_add_u32 s34, s30, 12288
    buffer_load_dwordx4 v[140:143], v1, s[8:11], s34 offen offset:0 nt
    v_dot2_f32_bf16 v28, v112, v2, 0
    v_dot2_f32_bf16 v28, v113, v3, v28
    v_dot2_f32_bf16 v28, v114, v4, v28
    v_dot2_f32_bf16 v28, v115, v5, v28
    s_waitcnt vmcnt(4)
    s_add_u32 s34, s30, 16384
    buffer_load_dwordx4 v[144:147], v1, s[8:11], s34 offen offset:0 nt
    v_dot2_f32_bf16 v29, v116, v2, 0
    v_dot2_f32_bf16 v29, v117, v3, v29
    v_dot2_f32_bf16 v29, v118, v4, v29
    v_dot2_f32_bf16 v29, v119, v5, v29
    s_waitcnt vmcnt(4)
    s_add_u32 s34, s30, 20480
    buffer_load_dwordx4 v[148:151], v1, s[8:11], s34 offen offset:0 nt
    v_dot2_f32_bf16 v30, v120, v2, 0
    v_dot2_f32_bf16 v30, v121, v3, v30
    v_dot2_f32_bf16 v30, v122, v4, v30
    v_dot2_f32_bf16 v30, v123, v5, v30
    s_waitcnt vmcnt(4)
    s_add_u32 s34, s30, 24576
    buffer_load_dwordx4 v[152:155], v1, s[8:11], s34 offen offset:0 nt
    v_dot2_f32_bf16 v31, v124, v2, 0
    v_dot2_f32_bf16 v31, v125, v3, v31
    v_dot2_f32_bf16 v31, v126, v4, v31
    v_dot2_f32_bf16 v31, v127, v5, v31
    v_add_f32_dpp v16, v16, v16 row_ror:8 row_mask:0xf bank_mask:0x3
    v_add_f32_dpp v17, v17, v17 row_ror:8 row_mask:0xf bank_mask:0x3
    v_add_f32_dpp v18, v18, v18 row_ror:8 row_mask:0xf bank_mask:0x3
    v_add_f32_dpp v19, v19, v19 row_ror:8 row_mask:0xf bank_mask:0x3
    v_add_f32_dpp v20, v20, v20 row_ror:8 row_mask:0xf bank_mask:0x3
    v_add_f32_dpp v21, v21, v21 row_ror:8 row_mask:0xf bank_mask:0x3
    v_add_f32_dpp v22, v22, v22 row_ror:8 row_mask:0xf bank_mask:0x3
    v_add_f32_dpp v23, v23, v23 row_ror:8 row_mask:0xf bank_mask:0x3
    v_add_f32_dpp v16, v24, v24 row_ror:8 row_mask:0xf bank_mask:0xc
    v_add_f32_dpp v17, v25, v25 row_ror:8 row_mask:0xf bank_mask:0xc
    v_add_f32_dpp v18, v26, v26 row_ror:8 row_mask:0xf bank_mask:0xc
    v_add_f32_dpp v19, v27, v27 row_ror:8 row_mask:0xf bank_mask:0xc
    v_add_f32_dpp v20, v28, v28 row_ror:8 row_mask:0xf bank_mask:0xc
    v_add_f32_dpp v21, v29, v29 row_ror:8 row_mask:0xf bank_mask:0xc
    v_add_f32_dpp v22, v30, v30 row_ror:8 row_mask:0xf bank_mask:0xc
    v_add_f32_dpp v23, v31, v31 row_ror:8 row_mask:0xf bank_mask:0xc
    v_add_f32_dpp v16, v16, v16 row_half_mirror row_mask:0xf bank_mask:0x5
    v_add_f32_dpp v17, v17, v17 row_half_mirror row_mask:0xf bank_mask:0x5
    v_add_f32_dpp v18, v18, v18 row_half_mirror row_mask:0xf bank_mask:0x5
    v_add_f32_dpp v19, v19, v19 row_half_mirror row_mask:0xf bank_mask:0x5
    v_add_f32_dpp v16, v20, v20 row_half_mirror row_mask:0xf bank_mask:0xa
    v_add_f32_dpp v17, v21, v21 row_half_mirror row_mask:0xf bank_mask:0xa
    v_add_f32_dpp v18, v22, v22 row_half_mirror row_mask:0xf bank_mask:0xa
    v_add_f32_dpp v19, v23, v23 row_half_mirror row_mask:0xf bank_mask:0xa
    v_add_f32_dpp v20, v16, v16 quad_perm:[2,3,0,1] row_mask:0xf bank_mask:0xf
    v_add_f32_dpp v21, v17, v17 quad_perm:[2,3,0,1] row_mask:0xf bank_mask:0xf
    v_add_f32_dpp v22, v18, v18 quad_perm:[2,3,0,1] row_mask:0xf bank_mask:0xf
    v_add_f32_dpp v23, v19, v19 quad_perm:[2,3,0,1] row_mask:0xf bank_mask:0xf
    v_cndmask_b32 v16, v20, v22, s[36:37]
    v_cndmask_b32 v17, v21, v23, s[36:37]
    s_nop 0
    v_add_f32_dpp v18, v16, v16 quad_perm:[1,0,3,2] row_mask:0xf bank_mask:0xf
    v_add_f32_dpp v19, v17, v17 quad_perm:[1,0,3,2] row_mask:0xf bank_mask:0xf
    v_cndmask_b32 v16, v18, v19, s[38:39]
    v_cndmask_b32 v17, v18, v19, s[38:39]
    s_nop 1
    v_permlane16_swap_b32 v16, v17
    v_add_f32 v16, v16, v17
    v_cvt_pk_bf16_f32 v16, v16, v16
    v_and_b32 v16, 0xffff0000, v16
    v_max_f32 v48, v16, v48
    v_mov_b32 v192, v194
    v_mov_b32 v193, v195
    v_mov_b32 v194, v196
    v_mov_b32 v195, v197
    v_mov_b32 v196, v198
    v_mov_b32 v197, v199
    v_mov_b32 v198, v200
    v_mov_b32 v199, v201
    v_mov_b32 v200, v202
    v_mov_b32 v201, v203
    v_mov_b32 v202, v204
    v_mov_b32 v203, v205
    v_mov_b32 v204, v206
    v_mov_b32 v205, v207
    v_mov_b32 v206, v16
    s_waitcnt vmcnt(4)
    s_add_u32 s34, s30, 28672
    buffer_load_dwordx4 v[156:159], v1, s[8:11], s34 offen offset:0 nt
    v_dot2_f32_bf16 v16, v128, v2, 0
    v_dot2_f32_bf16 v16, v129, v3, v16
    v_dot2_f32_bf16 v16, v130, v4, v16
    v_dot2_f32_bf16 v16, v131, v5, v16
    s_waitcnt vmcnt(4)
    s_add_u32 s34, s30, 131072
    buffer_load_dwordx4 v[160:163], v1, s[8:11], s34 offen offset:0 nt
    v_dot2_f32_bf16 v17, v132, v2, 0
    v_dot2_f32_bf16 v17, v133, v3, v17
    v_dot2_f32_bf16 v17, v134, v4, v17
    v_dot2_f32_bf16 v17, v135, v5, v17
    s_waitcnt vmcnt(4)
    s_add_u32 s34, s30, 135168
    buffer_load_dwordx4 v[164:167], v1, s[8:11], s34 offen offset:0 nt
    v_dot2_f32_bf16 v18, v136, v2, 0
    v_dot2_f32_bf16 v18, v137, v3, v18
    v_dot2_f32_bf16 v18, v138, v4, v18
    v_dot2_f32_bf16 v18, v139, v5, v18
    s_waitcnt vmcnt(4)
    s_add_u32 s34, s30, 139264
    buffer_load_dwordx4 v[168:171], v1, s[8:11], s34 offen offset:0 nt
    v_dot2_f32_bf16 v19, v140, v2, 0
    v_dot2_f32_bf16 v19, v141, v3, v19
    v_dot2_f32_bf16 v19, v142, v4, v19
    v_dot2_f32_bf16 v19, v143, v5, v19
    s_waitcnt vmcnt(4)
    s_add_u32 s34, s30, 143360
    buffer_load_dwordx4 v[172:175], v1, s[8:11], s34 offen offset:0 nt
    v_dot2_f32_bf16 v20, v144, v2, 0
    v_dot2_f32_bf16 v20, v145, v3, v20
    v_dot2_f32_bf16 v20, v146, v4, v20
    v_dot2_f32_bf16 v20, v147, v5, v20
    s_waitcnt vmcnt(4)
    s_add_u32 s34, s30, 147456
    buffer_load_dwordx4 v[176:179], v1, s[8:11], s34 offen offset:0 nt
    v_dot2_f32_bf16 v21, v148, v2, 0
    v_dot2_f32_bf16 v21, v149, v3, v21
    v_dot2_f32_bf16 v21, v150, v4, v21
    v_dot2_f32_bf16 v21, v151, v5, v21
    s_waitcnt vmcnt(4)
    s_add_u32 s34, s30, 151552
    buffer_load_dwordx4 v[180:183], v1, s[8:11], s34 offen offset:0 nt
    v_dot2_f32_bf16 v22, v152, v2, 0
    v_dot2_f32_bf16 v22, v153, v3, v22
    v_dot2_f32_bf16 v22, v154, v4, v22
    v_dot2_f32_bf16 v22, v155, v5, v22
    s_waitcnt vmcnt(4)
    s_add_u32 s34, s30, 155648
    buffer_load_dwordx4 v[184:187], v1, s[8:11], s34 offen offset:0 nt
    v_dot2_f32_bf16 v23, v156, v2, 0
    v_dot2_f32_bf16 v23, v157, v3, v23
    v_dot2_f32_bf16 v23, v158, v4, v23
    v_dot2_f32_bf16 v23, v159, v5, v23
    s_waitcnt vmcnt(4)
    s_add_u32 s34, s30, 159744
    buffer_load_dwordx4 v[188:191], v1, s[8:11], s34 offen offset:0 nt
    s_or_b32 s30, s30, 0x6ffff
    s_add_u32 s30, s30, 1
    s_bitcmp1_b32 s30, 21
    s_cselect_b32 s8, s44, s8
    s_cselect_b32 s9, s45, s9
    s_and_b32 s30, s30, 0x190000
    s_or_b32 s30, s30, 0x40000
    v_dot2_f32_bf16 v24, v160, v2, 0
    v_dot2_f32_bf16 v24, v161, v3, v24
    v_dot2_f32_bf16 v24, v162, v4, v24
    v_dot2_f32_bf16 v24, v163, v5, v24
    s_waitcnt vmcnt(4)
    buffer_load_dwordx4 v[64:67], v1, s[4:7], s24 offen offset:0 nt
    v_dot2_f32_bf16 v25, v164, v2, 0
    v_dot2_f32_bf16 v25, v165, v3, v25
    v_dot2_f32_bf16 v25, v166, v4, v25
    v_dot2_f32_bf16 v25, v167, v5, v25
    s_waitcnt vmcnt(4)
    s_add_u32 s34, s24, 4096
    buffer_load_dwordx4 v[68:71], v1, s[4:7], s34 offen offset:0 nt
    v_dot2_f32_bf16 v26, v168, v2, 0
    v_dot2_f32_bf16 v26, v169, v3, v26
    v_dot2_f32_bf16 v26, v170, v4, v26
    v_dot2_f32_bf16 v26, v171, v5, v26
    s_waitcnt vmcnt(4)
    s_add_u32 s34, s24, 8192
    buffer_load_dwordx4 v[72:75], v1, s[4:7], s34 offen offset:0 nt
    v_dot2_f32_bf16 v27, v172, v2, 0
    v_dot2_f32_bf16 v27, v173, v3, v27
    v_dot2_f32_bf16 v27, v174, v4, v27
    v_dot2_f32_bf16 v27, v175, v5, v27
    s_waitcnt vmcnt(4)
    s_add_u32 s34, s24, 12288
    buffer_load_dwordx4 v[76:79], v1, s[4:7], s34 offen offset:0 nt
    v_dot2_f32_bf16 v28, v176, v2, 0
    v_dot2_f32_bf16 v28, v177, v3, v28
    v_dot2_f32_bf16 v28, v178, v4, v28
    v_dot2_f32_bf16 v28, v179, v5, v28
    s_waitcnt vmcnt(4)
    s_add_u32 s34, s24, 16384
    buffer_load_dwordx4 v[80:83], v1, s[4:7], s34 offen offset:0 nt
    v_sub_u32 v57, v56, v58
    v_mov_b32 v58, v56
    v_add_u32 v56, v56, v57
    v_subrev_u32 v56, s68, v56
    v_and_b32 v57, 0x3ff, v56
    v_cmp_eq_u32 s[70:71], 0, v57
    v_cmp_gt_i32 vcc, 0xffff6000, v56
    s_and_b32 s72, vcc_lo, s70
    v_cmp_lt_i32 vcc, 0xf000, v56
    s_bcnt1_i32_b32 s72, s72
    s_orn2_b32 s73, vcc_lo, s70
    s_bcnt1_i32_b32 s73, s73
    s_cmp_gt_u32 s73, 16
    s_cselect_b32 s78, 1, 0
    s_cmp_ge_u32 s72, 16
    s_cselect_b32 s78, 2, s78
    s_cmp_ge_u32 s33, 12
    s_cselect_b32 s78, 0, s78
    v_dot2_f32_bf16 v29, v180, v2, 0
    v_dot2_f32_bf16 v29, v181, v3, v29
    v_dot2_f32_bf16 v29, v182, v4, v29
    v_dot2_f32_bf16 v29, v183, v5, v29
    s_waitcnt vmcnt(4)
    s_add_u32 s34, s24, 20480
    buffer_load_dwordx4 v[84:87], v1, s[4:7], s34 offen offset:0 nt
    v_dot2_f32_bf16 v30, v184, v2, 0
    v_dot2_f32_bf16 v30, v185, v3, v30
    v_dot2_f32_bf16 v30, v186, v4, v30
    v_dot2_f32_bf16 v30, v187, v5, v30
    s_waitcnt vmcnt(4)
    s_add_u32 s34, s24, 24576
    buffer_load_dwordx4 v[88:91], v1, s[4:7], s34 offen offset:0 nt
    v_dot2_f32_bf16 v31, v188, v2, 0
    v_dot2_f32_bf16 v31, v189, v3, v31
    v_dot2_f32_bf16 v31, v190, v4, v31
    v_dot2_f32_bf16 v31, v191, v5, v31
    v_add_f32_dpp v16, v16, v16 row_ror:8 row_mask:0xf bank_mask:0x3
    v_add_f32_dpp v17, v17, v17 row_ror:8 row_mask:0xf bank_mask:0x3
    v_add_f32_dpp v18, v18, v18 row_ror:8 row_mask:0xf bank_mask:0x3
    v_add_f32_dpp v19, v19, v19 row_ror:8 row_mask:0xf bank_mask:0x3
    v_add_f32_dpp v20, v20, v20 row_ror:8 row_mask:0xf bank_mask:0x3
    v_add_f32_dpp v21, v21, v21 row_ror:8 row_mask:0xf bank_mask:0x3
    v_add_f32_dpp v22, v22, v22 row_ror:8 row_mask:0xf bank_mask:0x3
    v_add_f32_dpp v23, v23, v23 row_ror:8 row_mask:0xf bank_mask:0x3
    v_add_f32_dpp v16, v24, v24 row_ror:8 row_mask:0xf bank_mask:0xc
    v_add_f32_dpp v17, v25, v25 row_ror:8 row_mask:0xf bank_mask:0xc
    v_add_f32_dpp v18, v26, v26 row_ror:8 row_mask:0xf bank_mask:0xc
    v_add_f32_dpp v19, v27, v27 row_ror:8 row_mask:0xf bank_mask:0xc
    v_add_f32_dpp v20, v28, v28 row_ror:8 row_mask:0xf bank_mask:0xc
    v_add_f32_dpp v21, v29, v29 row_ror:8 row_mask:0xf bank_mask:0xc
    v_add_f32_dpp v22, v30, v30 row_ror:8 row_mask:0xf bank_mask:0xc
    v_add_f32_dpp v23, v31, v31 row_ror:8 row_mask:0xf bank_mask:0xc
    v_add_f32_dpp v16, v16, v16 row_half_mirror row_mask:0xf bank_mask:0x5
    v_add_f32_dpp v17, v17, v17 row_half_mirror row_mask:0xf bank_mask:0x5
    v_add_f32_dpp v18, v18, v18 row_half_mirror row_mask:0xf bank_mask:0x5
    v_add_f32_dpp v19, v19, v19 row_half_mirror row_mask:0xf bank_mask:0x5
    v_add_f32_dpp v16, v20, v20 row_half_mirror row_mask:0xf bank_mask:0xa
    v_add_f32_dpp v17, v21, v21 row_half_mirror row_mask:0xf bank_mask:0xa
    v_add_f32_dpp v18, v22, v22 row_half_mirror row_mask:0xf bank_mask:0xa
    v_add_f32_dpp v19, v23, v23 row_half_mirror row_mask:0xf bank_mask:0xa
    v_add_f32_dpp v20, v16, v16 quad_perm:[2,3,0,1] row_mask:0xf bank_mask:0xf
    v_add_f32_dpp v21, v17, v17 quad_perm:[2,3,0,1] row_mask:0xf bank_mask:0xf
    v_add_f32_dpp v22, v18, v18 quad_perm:[2,3,0,1] row_mask:0xf bank_mask:0xf
    v_add_f32_dpp v23, v19, v19 quad_perm:[2,3,0,1] row_mask:0xf bank_mask:0xf
    v_cndmask_b32 v16, v20, v22, s[36:37]
    v_cndmask_b32 v17, v21, v23, s[36:37]
    s_nop 0
    v_add_f32_dpp v18, v16, v16 quad_perm:[1,0,3,2] row_mask:0xf bank_mask:0xf
    v_add_f32_dpp v19, v17, v17 quad_perm:[1,0,3,2] row_mask:0xf bank_mask:0xf
    v_cndmask_b32 v16, v18, v19, s[38:39]
    v_cndmask_b32 v17, v18, v19, s[38:39]
    s_nop 1
    v_permlane16_swap_b32 v16, v17
    v_add_f32 v16, v16, v17
    v_cvt_pk_bf16_f32 v16, v16, v16
    v_and_b32 v16, 0xffff0000, v16
    v_max_f32 v48, v16, v48
    v_mov_b32 v207, v16
    s_sub_u32 s33, s33, 1
    s_cmp_lg_u32 s33, 7
    s_cbranch_scc1 L_loop
    s_branch L_soft
L_u2:
    s_waitcnt vmcnt(6)
    s_add_u32 s34, s24, 28672
    buffer_load_dwordx4 v[92:95], v1, s[4:7], s34 offen offset:0 nt
    v_dot2_f32_bf16 v16, v64, v2, 0
    v_dot2_f32_bf16 v16, v65, v3, v16
    v_dot2_f32_bf16 v16, v66, v4, v16
    v_dot2_f32_bf16 v16, v67, v5, v16
    s_waitcnt vmcnt(6)
    s_add_u32 s34, s24, 131072
    buffer_load_dwordx4 v[96:99], v1, s[4:7], s34 offen offset:0 nt
    v_dot2_f32_bf16 v17, v68, v2, 0
    v_dot2_f32_bf16 v17, v69, v3, v17
    v_dot2_f32_bf16 v17, v70, v4, v17
    v_dot2_f32_bf16 v17, v71, v5, v17
    s_waitcnt vmcnt(6)
    s_add_u32 s34, s24, 135168
    buffer_load_dwordx4 v[100:103], v1, s[4:7], s34 offen offset:0 nt
    s_waitcnt lgkmcnt(0)
    s_mov_b32 s79, s68
    s_lshl_b32 s68, s66, 10
    s_or_b32 s68, s68, s65
    s_mov_b32 s77, s69
    s_sub_u32 s69, s69, 4096
    v_mov_b32 v53, s68
    buffer_store_dword v53, v54, s[20:23], s69 offen sc1
    v_dot2_f32_bf16 v18, v72, v2, 0
    v_dot2_f32_bf16 v18, v73, v3, v18
    v_dot2_f32_bf16 v18, v74, v4, v18
    v_dot2_f32_bf16 v18, v75, v5, v18
    s_waitcnt vmcnt(6)
    s_add_u32 s34, s24, 139264
    buffer_load_dwordx4 v[104:107], v1, s[4:7], s34 offen offset:0 nt
    v_dot2_f32_bf16 v19, v76, v2, 0
    v_dot2_f32_bf16 v19, v77, v3, v19
    v_dot2_f32_bf16 v19, v78, v4, v19
    v_dot2_f32_bf16 v19, v79, v5, v19
    s_waitcnt vmcnt(6)
    s_add_u32 s34, s24, 143360
    buffer_load_dwordx4 v[108:111], v1, s[4:7], s34 offen offset:0 nt
    v_dot2_f32_bf16 v20, v80, v2, 0
    v_dot2_f32_bf16 v20, v81, v3, v20
    v_dot2_f32_bf16 v20, v82, v4, v20
    v_dot2_f32_bf16 v20, v83, v5, v20
    s_waitcnt vmcnt(6)
    s_add_u32 s34, s24, 147456
    buffer_load_dwordx4 v[112:115], v1, s[4:7], s34 offen offset:0 nt
    v_dot2_f32_bf16 v21, v84, v2, 0
    v_dot2_f32_bf16 v21, v85, v3, v21
    v_dot2_f32_bf16 v21, v86, v4, v21
    v_dot2_f32_bf16 v21, v87, v5, v21
    s_waitcnt vmcnt(6)
    s_add_u32 s34, s24, 151552
    buffer_load_dwordx4 v[116:119], v1, s[4:7], s34 offen offset:0 nt
    v_dot2_f32_bf16 v22, v88, v2, 0
    v_dot2_f32_bf16 v22, v89, v3, v22
    v_dot2_f32_bf16 v22, v90, v4, v22
    v_dot2_f32_bf16 v22, v91, v5, v22
    s_waitcnt vmcnt(6)
    s_add_u32 s34, s24, 155648
    buffer_load_dwordx4 v[120:123], v1, s[4:7], s34 offen offset:0 nt
    v_dot2_f32_bf16 v23, v92, v2, 0
    v_dot2_f32_bf16 v23, v93, v3, v23
    v_dot2_f32_bf16 v23, v94, v4, v23
    v_dot2_f32_bf16 v23, v95, v5, v23
    s_waitcnt vmcnt(6)
    s_add_u32 s34, s24, 159744
    buffer_load_dwordx4 v[124:127], v1, s[4:7], s34 offen offset:0 nt
    s_or_b32 s24, s24, 0x6ffff
    s_add_u32 s24, s24, 1
    s_bitcmp1_b32 s24, 21
    s_cselect_b32 s4, s44, s4
    s_cselect_b32 s5, s45, s5
    s_and_b32 s24, s24, 0x190000
    v_dot2_f32_bf16 v24, v96, v2, 0
    v_dot2_f32_bf16 v24, v97, v3, v24
    v_dot2_f32_bf16 v24, v98, v4, v24
    v_dot2_f32_bf16 v24, v99, v5, v24
    s_waitcnt vmcnt(6)
    buffer_load_dwordx4 v[128:131], v1, s[8:11], s30 offen offset:0 nt
    v_dot2_f32_bf16 v25, v100, v2, 0
    v_dot2_f32_bf16 v25, v101, v3, v25
    v_dot2_f32_bf16 v25, v102, v4, v25
    v_dot2_f32_bf16 v25, v103, v5, v25
    s_waitcnt vmcnt(6)
    s_add_u32 s34, s30, 4096
    buffer_load_dwordx4 v[132:135], v1, s[8:11], s34 offen offset:0 nt
    v_dot2_f32_bf16 v26, v104, v2, 0
    v_dot2_f32_bf16 v26, v105, v3, v26
    v_dot2_f32_bf16 v26, v106, v4, v26
    v_dot2_f32_bf16 v26, v107, v5, v26
    s_waitcnt vmcnt(6)
    s_add_u32 s34, s30, 8192
    buffer_load_dwordx4 v[136:139], v1, s[8:11], s34 offen offset:0 nt
    buffer_load_dword v56, v55, s[20:23], s77 offen
    v_dot2_f32_bf16 v27, v108, v2, 0
    v_dot2_f32_bf16 v27, v109, v3, v27
    v_dot2_f32_bf16 v27, v110, v4, v27
    v_dot2_f32_bf16 v27, v111, v5, v27
    s_waitcnt vmcnt(6)
    s_add_u32 s34, s30, 12288
    buffer_load_dwordx4 v[140:143], v1, s[8:11], s34 offen offset:0 nt
    v_dot2_f32_bf16 v28, v112, v2, 0
    v_dot2_f32_bf16 v28, v113, v3, v28
    v_dot2_f32_bf16 v28, v114, v4, v28
    v_dot2_f32_bf16 v28, v115, v5, v28
    s_waitcnt vmcnt(6)
    s_add_u32 s34, s30, 16384
    buffer_load_dwordx4 v[144:147], v1, s[8:11], s34 offen offset:0 nt
    v_dot2_f32_bf16 v29, v116, v2, 0
    v_dot2_f32_bf16 v29, v117, v3, v29
    v_dot2_f32_bf16 v29, v118, v4, v29
    v_dot2_f32_bf16 v29, v119, v5, v29
    s_waitcnt vmcnt(6)
    s_add_u32 s34, s30, 20480
    buffer_load_dwordx4 v[148:151], v1, s[8:11], s34 offen offset:0 nt
    v_dot2_f32_bf16 v30, v120, v2, 0
    v_dot2_f32_bf16 v30, v121, v3, v30
    v_dot2_f32_bf16 v30, v122, v4, v30
    v_dot2_f32_bf16 v30, v123, v5, v30
    s_waitcnt vmcnt(6)
    s_add_u32 s34, s30, 24576
    buffer_load_dwordx4 v[152:155], v1, s[8:11], s34 offen offset:0 nt
    v_dot2_f32_bf16 v31, v124, v2, 0
    v_dot2_f32_bf16 v31, v125, v3, v31
    v_dot2_f32_bf16 v31, v126, v4, v31
    v_dot2_f32_bf16 v31, v127, v5, v31
    v_add_f32_dpp v16, v16, v16 row_ror:8 row_mask:0xf bank_mask:0x3
    v_add_f32_dpp v17, v17, v17 row_ror:8 row_mask:0xf bank_mask:0x3
    v_add_f32_dpp v18, v18, v18 row_ror:8 row_mask:0xf bank_mask:0x3
    v_add_f32_dpp v19, v19, v19 row_ror:8 row_mask:0xf bank_mask:0x3
    v_add_f32_dpp v20, v20, v20 row_ror:8 row_mask:0xf bank_mask:0x3
    v_add_f32_dpp v21, v21, v21 row_ror:8 row_mask:0xf bank_mask:0x3
    v_add_f32_dpp v22, v22, v22 row_ror:8 row_mask:0xf bank_mask:0x3
    v_add_f32_dpp v23, v23, v23 row_ror:8 row_mask:0xf bank_mask:0x3
    v_add_f32_dpp v16, v24, v24 row_ror:8 row_mask:0xf bank_mask:0xc
    v_add_f32_dpp v17, v25, v25 row_ror:8 row_mask:0xf bank_mask:0xc
    v_add_f32_dpp v18, v26, v26 row_ror:8 row_mask:0xf bank_mask:0xc
    v_add_f32_dpp v19, v27, v27 row_ror:8 row_mask:0xf bank_mask:0xc
    v_add_f32_dpp v20, v28, v28 row_ror:8 row_mask:0xf bank_mask:0xc
    v_add_f32_dpp v21, v29, v29 row_ror:8 row_mask:0xf bank_mask:0xc
    v_add_f32_dpp v22, v30, v30 row_ror:8 row_mask:0xf bank_mask:0xc
    v_add_f32_dpp v23, v31, v31 row_ror:8 row_mask:0xf bank_mask:0xc
    v_add_f32_dpp v16, v16, v16 row_half_mirror row_mask:0xf bank_mask:0x5
    v_add_f32_dpp v17, v17, v17 row_half_mirror row_mask:0xf bank_mask:0x5
    v_add_f32_dpp v18, v18, v18 row_half_mirror row_mask:0xf bank_mask:0x5
    v_add_f32_dpp v19, v19, v19 row_half_mirror row_mask:0xf bank_mask:0x5
    v_add_f32_dpp v16, v20, v20 row_half_mirror row_mask:0xf bank_mask:0xa
    v_add_f32_dpp v17, v21, v21 row_half_mirror row_mask:0xf bank_mask:0xa
    v_add_f32_dpp v18, v22, v22 row_half_mirror row_mask:0xf bank_mask:0xa
    v_add_f32_dpp v19, v23, v23 row_half_mirror row_mask:0xf bank_mask:0xa
    v_add_f32_dpp v20, v16, v16 quad_perm:[2,3,0,1] row_mask:0xf bank_mask:0xf
    v_add_f32_dpp v21, v17, v17 quad_perm:[2,3,0,1] row_mask:0xf bank_mask:0xf
    v_add_f32_dpp v22, v18, v18 quad_perm:[2,3,0,1] row_mask:0xf bank_mask:0xf
    v_add_f32_dpp v23, v19, v19 quad_perm:[2,3,0,1] row_mask:0xf bank_mask:0xf
    v_cndmask_b32 v16, v20, v22, s[36:37]
    v_cndmask_b32 v17, v21, v23, s[36:37]
    s_nop 0
    v_add_f32_dpp v18, v16, v16 quad_perm:[1,0,3,2] row_mask:0xf bank_mask:0xf
    v_add_f32_dpp v19, v17, v17 quad_perm:[1,0,3,2] row_mask:0xf bank_mask:0xf
    v_cndmask_b32 v16, v18, v19, s[38:39]
    v_cndmask_b32 v17, v18, v19, s[38:39]
    s_nop 1
    v_permlane16_swap_b32 v16, v17
    v_add_f32 v16, v16, v17
    v_cvt_pk_bf16_f32 v16, v16, v16
    v_and_b32 v16, 0xffff0000, v16
    v_max_f32 v48, v16, v48
    v_mov_b32 v192, v194
    v_mov_b32 v193, v195
    v_mov_b32 v194, v196
    v_mov_b32 v195, v197
    v_mov_b32 v196, v198
    v_mov_b32 v197, v199
    v_mov_b32 v198, v200
    v_mov_b32 v199, v201
    v_mov_b32 v200, v202
    v_mov_b32 v201, v203
    v_mov_b32 v202, v204
    v_mov_b32 v203, v205
    v_mov_b32 v204, v206
    v_mov_b32 v205, v207
    v_mov_b32 v206, v16
    s_waitcnt vmcnt(6)
    s_add_u32 s34, s30, 28672
    buffer_load_dwordx4 v[156:159], v1, s[8:11], s34 offen offset:0 nt
    v_dot2_f32_bf16 v16, v128, v2, 0
    v_dot2_f32_bf16 v16, v129, v3, v16
    v_dot2_f32_bf16 v16, v130, v4, v16
    v_dot2_f32_bf16 v16, v131, v5, v16
    s_waitcnt vmcnt(6)
    s_add_u32 s34, s30, 131072
    buffer_load_dwordx4 v[160:163], v1, s[8:11], s34 offen offset:0 nt
    v_dot2_f32_bf16 v17, v132, v2, 0
    v_dot2_f32_bf16 v17, v133, v3, v17
    v_dot2_f32_bf16 v17, v134, v4, v17
    v_dot2_f32_bf16 v17, v135, v5, v17
    s_waitcnt vmcnt(6)
    s_add_u32 s34, s30, 135168
    buffer_load_dwordx4 v[164:167], v1, s[8:11], s34 offen offset:0 nt
    v_dot2_f32_bf16 v18, v136, v2, 0
    v_dot2_f32_bf16 v18, v137, v3, v18
    v_dot2_f32_bf16 v18, v138, v4, v18
    v_dot2_f32_bf16 v18, v139, v5, v18
    s_waitcnt vmcnt(6)
    s_add_u32 s34, s30, 139264
    buffer_load_dwordx4 v[168:171], v1, s[8:11], s34 offen offset:0 nt
    v_dot2_f32_bf16 v19, v140, v2, 0
    v_dot2_f32_bf16 v19, v141, v3, v19
    v_dot2_f32_bf16 v19, v142, v4, v19
    v_dot2_f32_bf16 v19, v143, v5, v19
    s_waitcnt vmcnt(6)
    s_add_u32 s34, s30, 143360
    buffer_load_dwordx4 v[172:175], v1, s[8:11], s34 offen offset:0 nt
    v_dot2_f32_bf16 v20, v144, v2, 0
    v_dot2_f32_bf16 v20, v145, v3, v20
    v_dot2_f32_bf16 v20, v146, v4, v20
    v_dot2_f32_bf16 v20, v147, v5, v20
    s_waitcnt vmcnt(6)
    s_add_u32 s34, s30, 147456
    buffer_load_dwordx4 v[176:179], v1, s[8:11], s34 offen offset:0 nt
    v_dot2_f32_bf16 v21, v148, v2, 0
    v_dot2_f32_bf16 v21, v149, v3, v21
    v_dot2_f32_bf16 v21, v150, v4, v21
    v_dot2_f32_bf16 v21, v151, v5, v21
    s_waitcnt vmcnt(6)
    s_add_u32 s34, s30, 151552
    buffer_load_dwordx4 v[180:183], v1, s[8:11], s34 offen offset:0 nt
    v_dot2_f32_bf16 v22, v152, v2, 0
    v_dot2_f32_bf16 v22, v153, v3, v22
    v_dot2_f32_bf16 v22, v154, v4, v22
    v_dot2_f32_bf16 v22, v155, v5, v22
    s_waitcnt vmcnt(6)
    s_add_u32 s34, s30, 155648
    buffer_load_dwordx4 v[184:187], v1, s[8:11], s34 offen offset:0 nt
    v_dot2_f32_bf16 v23, v156, v2, 0
    v_dot2_f32_bf16 v23, v157, v3, v23
    v_dot2_f32_bf16 v23, v158, v4, v23
    v_dot2_f32_bf16 v23, v159, v5, v23
    s_waitcnt vmcnt(6)
    s_add_u32 s34, s30, 159744
    buffer_load_dwordx4 v[188:191], v1, s[8:11], s34 offen offset:0 nt
    s_or_b32 s30, s30, 0x6ffff
    s_add_u32 s30, s30, 1
    s_bitcmp1_b32 s30, 21
    s_cselect_b32 s8, s44, s8
    s_cselect_b32 s9, s45, s9
    s_and_b32 s30, s30, 0x190000
    s_or_b32 s30, s30, 0x40000
    v_dot2_f32_bf16 v24, v160, v2, 0
    v_dot2_f32_bf16 v24, v161, v3, v24
    v_dot2_f32_bf16 v24, v162, v4, v24
    v_dot2_f32_bf16 v24, v163, v5, v24
    s_waitcnt vmcnt(6)
    buffer_load_dwordx4 v[64:67], v1, s[4:7], s24 offen offset:0 nt
    v_dot2_f32_bf16 v25, v164, v2, 0
    v_dot2_f32_bf16 v25, v165, v3, v25
    v_dot2_f32_bf16 v25, v166, v4, v25
    v_dot2_f32_bf16 v25, v167, v5, v25
    s_waitcnt vmcnt(6)
    s_add_u32 s34, s24, 4096
    buffer_load_dwordx4 v[68:71], v1, s[4:7], s34 offen offset:0 nt
    v_dot2_f32_bf16 v26, v168, v2, 0
    v_dot2_f32_bf16 v26, v169, v3, v26
    v_dot2_f32_bf16 v26, v170, v4, v26
    v_dot2_f32_bf16 v26, v171, v5, v26
    s_waitcnt vmcnt(6)
    s_add_u32 s34, s24, 8192
    buffer_load_dwordx4 v[72:75], v1, s[4:7], s34 offen offset:0 nt
    v_dot2_f32_bf16 v27, v172, v2, 0
    v_dot2_f32_bf16 v27, v173, v3, v27
    v_dot2_f32_bf16 v27, v174, v4, v27
    v_dot2_f32_bf16 v27, v175, v5, v27
    s_waitcnt vmcnt(6)
    s_add_u32 s34, s24, 12288
    buffer_load_dwordx4 v[76:79], v1, s[4:7], s34 offen offset:0 nt
    v_dot2_f32_bf16 v28, v176, v2, 0
    v_dot2_f32_bf16 v28, v177, v3, v28
    v_dot2_f32_bf16 v28, v178, v4, v28
    v_dot2_f32_bf16 v28, v179, v5, v28
    s_waitcnt vmcnt(6)
    s_add_u32 s34, s24, 16384
    buffer_load_dwordx4 v[80:83], v1, s[4:7], s34 offen offset:0 nt
    v_sub_u32 v57, v56, v58
    v_mov_b32 v58, v56
    v_add_u32 v56, v56, v57
    v_subrev_u32 v56, s68, v56
    v_and_b32 v57, 0x3ff, v56
    v_cmp_eq_u32 s[70:71], 0, v57
    v_cmp_gt_i32 vcc, 0xffff6000, v56
    s_and_b32 s72, vcc_lo, s70
    v_cmp_lt_i32 vcc, 0xf000, v56
    s_bcnt1_i32_b32 s72, s72
    s_orn2_b32 s73, vcc_lo, s70
    s_bcnt1_i32_b32 s73, s73
    s_cmp_gt_u32 s73, 16
    s_cselect_b32 s78, 1, 0
    s_cmp_ge_u32 s72, 16
    s_cselect_b32 s78, 2, s78
    s_cmp_ge_u32 s33, 12
    s_cselect_b32 s78, 0, s78
    v_dot2_f32_bf16 v29, v180, v2, 0
    v_dot2_f32_bf16 v29, v181, v3, v29
    v_dot2_f32_bf16 v29, v182, v4, v29
    v_dot2_f32_bf16 v29, v183, v5, v29
    s_waitcnt vmcnt(6)
    s_add_u32 s34, s24, 20480
    buffer_load_dwordx4 v[84:87], v1, s[4:7], s34 offen offset:0 nt
    v_dot2_f32_bf16 v30, v184, v2, 0
    v_dot2_f32_bf16 v30, v185, v3, v30
    v_dot2_f32_bf16 v30, v186, v4, v30
    v_dot2_f32_bf16 v30, v187, v5, v30
    s_waitcnt vmcnt(6)
    s_add_u32 s34, s24, 24576
    buffer_load_dwordx4 v[88:91], v1, s[4:7], s34 offen offset:0 nt
    v_dot2_f32_bf16 v31, v188, v2, 0
    v_dot2_f32_bf16 v31, v189, v3, v31
    v_dot2_f32_bf16 v31, v190, v4, v31
    v_dot2_f32_bf16 v31, v191, v5, v31
    v_add_f32_dpp v16, v16, v16 row_ror:8 row_mask:0xf bank_mask:0x3
    v_add_f32_dpp v17, v17, v17 row_ror:8 row_mask:0xf bank_mask:0x3
    v_add_f32_dpp v18, v18, v18 row_ror:8 row_mask:0xf bank_mask:0x3
    v_add_f32_dpp v19, v19, v19 row_ror:8 row_mask:0xf bank_mask:0x3
    v_add_f32_dpp v20, v20, v20 row_ror:8 row_mask:0xf bank_mask:0x3
    v_add_f32_dpp v21, v21, v21 row_ror:8 row_mask:0xf bank_mask:0x3
    v_add_f32_dpp v22, v22, v22 row_ror:8 row_mask:0xf bank_mask:0x3
    v_add_f32_dpp v23, v23, v23 row_ror:8 row_mask:0xf bank_mask:0x3
    v_add_f32_dpp v16, v24, v24 row_ror:8 row_mask:0xf bank_mask:0xc
    v_add_f32_dpp v17, v25, v25 row_ror:8 row_mask:0xf bank_mask:0xc
    v_add_f32_dpp v18, v26, v26 row_ror:8 row_mask:0xf bank_mask:0xc
    v_add_f32_dpp v19, v27, v27 row_ror:8 row_mask:0xf bank_mask:0xc
    v_add_f32_dpp v20, v28, v28 row_ror:8 row_mask:0xf bank_mask:0xc
    v_add_f32_dpp v21, v29, v29 row_ror:8 row_mask:0xf bank_mask:0xc
    v_add_f32_dpp v22, v30, v30 row_ror:8 row_mask:0xf bank_mask:0xc
    v_add_f32_dpp v23, v31, v31 row_ror:8 row_mask:0xf bank_mask:0xc
    v_add_f32_dpp v16, v16, v16 row_half_mirror row_mask:0xf bank_mask:0x5
    v_add_f32_dpp v17, v17, v17 row_half_mirror row_mask:0xf bank_mask:0x5
    v_add_f32_dpp v18, v18, v18 row_half_mirror row_mask:0xf bank_mask:0x5
    v_add_f32_dpp v19, v19, v19 row_half_mirror row_mask:0xf bank_mask:0x5
    v_add_f32_dpp v16, v20, v20 row_half_mirror row_mask:0xf bank_mask:0xa
    v_add_f32_dpp v17, v21, v21 row_half_mirror row_mask:0xf bank_mask:0xa
    v_add_f32_dpp v18, v22, v22 row_half_mirror row_mask:0xf bank_mask:0xa
    v_add_f32_dpp v19, v23, v23 row_half_mirror row_mask:0xf bank_mask:0xa
    v_add_f32_dpp v20, v16, v16 quad_perm:[2,3,0,1] row_mask:0xf bank_mask:0xf
    v_add_f32_dpp v21, v17, v17 quad_perm:[2,3,0,1] row_mask:0xf bank_mask:0xf
    v_add_f32_dpp v22, v18, v18 quad_perm:[2,3,0,1] row_mask:0xf bank_mask:0xf
    v_add_f32_dpp v23, v19, v19 quad_perm:[2,3,0,1] row_mask:0xf bank_mask:0xf
    v_cndmask_b32 v16, v20, v22, s[36:37]
    v_cndmask_b32 v17, v21, v23, s[36:37]
    s_nop 0
    v_add_f32_dpp v18, v16, v16 quad_perm:[1,0,3,2] row_mask:0xf bank_mask:0xf
    v_add_f32_dpp v19, v17, v17 quad_perm:[1,0,3,2] row_mask:0xf bank_mask:0xf
    v_cndmask_b32 v16, v18, v19, s[38:39]
    v_cndmask_b32 v17, v18, v19, s[38:39]
    s_nop 1
    v_permlane16_swap_b32 v16, v17
    v_add_f32 v16, v16, v17
    v_cvt_pk_bf16_f32 v16, v16, v16
    v_and_b32 v16, 0xffff0000, v16
    v_max_f32 v48, v16, v48
    v_mov_b32 v207, v16
    s_sub_u32 s33, s33, 1
    s_cmp_lg_u32 s33, 7
    s_cbranch_scc1 L_loop
L_soft:
    s_nop 1
    v_max_f32_dpp v48, v48, v48 quad_perm:[1,0,3,2] row_mask:0xf bank_mask:0xf
    s_nop 1
    v_max_f32_dpp v48, v48, v48 quad_perm:[2,3,0,1] row_mask:0xf bank_mask:0xf
    s_nop 1
    v_max_f32_dpp v48, v48, v48 row_half_mirror row_mask:0xf bank_mask:0xf
    s_nop 1
    v_max_f32_dpp v48, v48, v48 row_ror:8 row_mask:0xf bank_mask:0xf
    v_mov_b32 v18, v48
    s_nop 1
    v_permlane32_swap_b32 v48, v18
    v_max_f32 v48, v48, v18
    v_sub_f32 v192, v192, v48
    v_sub_f32 v193, v193, v48
    v_sub_f32 v194, v194, v48
    v_sub_f32 v195, v195, v48
    v_sub_f32 v196, v196, v48
    v_sub_f32 v197, v197, v48
    v_sub_f32 v198, v198, v48
    v_sub_f32 v199, v199, v48
    v_sub_f32 v200, v200, v48
    v_sub_f32 v201, v201, v48
    v_sub_f32 v202, v202, v48
    v_sub_f32 v203, v203, v48
    v_sub_f32 v204, v204, v48
    v_sub_f32 v205, v205, v48
    v_sub_f32 v206, v206, v48
    v_sub_f32 v207, v207, v48
    v_mul_f32 v192, s64, v192
    v_mul_f32 v193, s64, v193
    v_mul_f32 v194, s64, v194
    v_mul_f32 v195, s64, v195
    v_mul_f32 v196, s64, v196
    v_mul_f32 v197, s64, v197
    v_mul_f32 v198, s64, v198
    v_mul_f32 v199, s64, v199
    v_mul_f32 v200, s64, v200
    v_mul_f32 v201, s64, v201
    v_mul_f32 v202, s64, v202
    v_mul_f32 v203, s64, v203
    v_mul_f32 v204, s64, v204
    v_mul_f32 v205, s64, v205
    v_mul_f32 v206, s64, v206
    v_mul_f32 v207, s64, v207
    v_exp_f32 v192, v192
    v_exp_f32 v193, v193
    v_exp_f32 v194, v194
    v_exp_f32 v195, v195
    v_exp_f32 v196, v196
    v_exp_f32 v197, v197
    v_exp_f32 v198, v198
    v_exp_f32 v199, v199
    v_exp_f32 v200, v200
    v_exp_f32 v201, v201
    v_exp_f32 v202, v202
    v_exp_f32 v203, v203
    v_exp_f32 v204, v204
    v_exp_f32 v205, v205
    v_exp_f32 v206, v206
    v_exp_f32 v207, v207
    v_add_f32 v14, v14, v192
    v_cvt_pk_bf16_f32 v192, v192, v192
    v_add_f32 v14, v14, v193
    v_cvt_pk_bf16_f32 v193, v193, v193
    v_add_f32 v14, v14, v194
    v_cvt_pk_bf16_f32 v194, v194, v194
    v_add_f32 v14, v14, v195
    v_cvt_pk_bf16_f32 v195, v195, v195
    v_add_f32 v14, v14, v196
    v_cvt_pk_bf16_f32 v196, v196, v196
    v_add_f32 v14, v14, v197
    v_cvt_pk_bf16_f32 v197, v197, v197
    v_add_f32 v14, v14, v198
    v_cvt_pk_bf16_f32 v198, v198, v198
    v_add_f32 v14, v14, v199
    v_cvt_pk_bf16_f32 v199, v199, v199
    v_add_f32 v14, v14, v200
    v_cvt_pk_bf16_f32 v200, v200, v200
    v_add_f32 v14, v14, v201
    v_cvt_pk_bf16_f32 v201, v201, v201
    v_add_f32 v14, v14, v202
    v_cvt_pk_bf16_f32 v202, v202, v202
    v_add_f32 v14, v14, v203
    v_cvt_pk_bf16_f32 v203, v203, v203
    v_add_f32 v14, v14, v204
    v_cvt_pk_bf16_f32 v204, v204, v204
    v_add_f32 v14, v14, v205
    v_cvt_pk_bf16_f32 v205, v205, v205
    v_add_f32 v14, v14, v206
    v_cvt_pk_bf16_f32 v206, v206, v206
    v_add_f32 v14, v14, v207
    v_cvt_pk_bf16_f32 v207, v207, v207
L_loop2:
    v_mov_b32 v51, s33
    ds_write_b32 v50, v51 offset:1024
    s_memrealtime s[66:67]
    s_cmp_eq_u32 s78, 1
    s_cbranch_scc1 L_v1
    s_cmp_eq_u32 s78, 2
    s_cbranch_scc1 L_v2
L_v0:
    v_and_b32_dpp v32, v192, v6 row_newbcast:0 row_mask:0xf bank_mask:0xf
    v_and_b32_dpp v33, v192, v7 row_newbcast:0 row_mask:0xf bank_mask:0xf
    v_and_b32_dpp v34, v192, v8 row_newbcast:0 row_mask:0xf bank_mask:0xf
    v_and_b32_dpp v35, v192, v9 row_newbcast:0 row_mask:0xf bank_mask:0xf
    v_and_b32_dpp v36, v192, v6 row_newbcast:1 row_mask:0xf bank_mask:0xf
    v_and_b32_dpp v37, v192, v7 row_newbcast:1 row_mask:0xf bank_mask:0xf
    v_and_b32_dpp v38, v192, v8 row_newbcast:1 row_mask:0xf bank_mask:0xf
    v_and_b32_dpp v39, v192, v9 row_newbcast:1 row_mask:0xf bank_mask:0xf
    s_waitcnt vmcnt(5)
    s_add_u32 s34, s24, 28672
    buffer_load_dwordx4 v[92:95], v1, s[4:7], s34 offen offset:0 nt
    v_mfma_f32_16x16x32_bf16 v[10:13], v[32:35], v[64:67], v[10:13]
    v_and_b32_dpp v32, v192, v6 row_newbcast:2 row_mask:0xf bank_mask:0xf
    v_and_b32_dpp v33, v192, v7 row_newbcast:2 row_mask:0xf bank_mask:0xf
    v_and_b32_dpp v34, v192, v8 row_newbcast:2 row_mask:0xf bank_mask:0xf
    v_and_b32_dpp v35, v192, v9 row_newbcast:2 row_mask:0xf bank_mask:0xf
    s_waitcnt vmcnt(5)
    s_add_u32 s34, s24, 131072
    buffer_load_dwordx4 v[96:99], v1, s[4:7], s34 offen offset:0 nt
    v_mfma_f32_16x16x32_bf16 v[10:13], v[36:39], v[68:71], v[10:13]
    v_and_b32_dpp v36, v192, v6 row_newbcast:3 row_mask:0xf bank_mask:0xf
    v_and_b32_dpp v37, v192, v7 row_newbcast:3 row_mask:0xf bank_mask:0xf
    v_and_b32_dpp v38, v192, v8 row_newbcast:3 row_mask:0xf bank_mask:0xf
    v_and_b32_dpp v39, v192, v9 row_newbcast:3 row_mask:0xf bank_mask:0xf
    s_waitcnt vmcnt(5)
    s_add_u32 s34, s24, 135168
    buffer_load_dwordx4 v[100:103], v1, s[4:7], s34 offen offset:0 nt
    s_waitcnt lgkmcnt(0)
    s_mov_b32 s79, s68
    s_lshl_b32 s68, s66, 10
    s_or_b32 s68, s68, s65
    s_mov_b32 s77, s69
    s_sub_u32 s69, s69, 4096
    v_mov_b32 v53, s68
    buffer_store_dword v53, v54, s[20:23], s69 offen sc1
    v_mfma_f32_16x16x32_bf16 v[10:13], v[32:35], v[72:75], v[10:13]
    v_and_b32_dpp v32, v192, v6 row_newbcast:4 row_mask:0xf bank_mask:0xf
    v_and_b32_dpp v33, v192, v7 row_newbcast:4 row_mask:0xf bank_mask:0xf
    v_and_b32_dpp v34, v192, v8 row_newbcast:4 row_mask:0xf bank_mask:0xf
    v_and_b32_dpp v35, v192, v9 row_newbcast:4 row_mask:0xf bank_mask:0xf
    s_waitcnt vmcnt(5)
    s_add_u32 s34, s24, 139264
    buffer_load_dwordx4 v[104:107], v1, s[4:7], s34 offen offset:0 nt
    v_mfma_f32_16x16x32_bf16 v[10:13], v[36:39], v[76:79], v[10:13]
    v_and_b32_dpp v36, v192, v6 row_newbcast:5 row_mask:0xf bank_mask:0xf
    v_and_b32_dpp v37, v192, v7 row_newbcast:5 row_mask:0xf bank_mask:0xf
    v_and_b32_dpp v38, v192, v8 row_newbcast:5 row_mask:0xf bank_mask:0xf
    v_and_b32_dpp v39, v192, v9 row_newbcast:5 row_mask:0xf bank_mask:0xf
    s_waitcnt vmcnt(5)
    s_add_u32 s34, s24, 143360
    buffer_load_dwordx4 v[108:111], v1, s[4:7], s34 offen offset:0 nt
    v_mfma_f32_16x16x32_bf16 v[10:13], v[32:35], v[80:83], v[10:13]
    v_and_b32_dpp v32, v192, v6 row_newbcast:6 row_mask:0xf bank_mask:0xf
    v_and_b32_dpp v33, v192, v7 row_newbcast:6 row_mask:0xf bank_mask:0xf
    v_and_b32_dpp v34, v192, v8 row_newbcast:6 row_mask:0xf bank_mask:0xf
    v_and_b32_dpp v35, v192, v9 row_newbcast:6 row_mask:0xf bank_mask:0xf
    s_waitcnt vmcnt(5)
    s_add_u32 s34, s24, 147456
    buffer_load_dwordx4 v[112:115], v1, s[4:7], s34 offen offset:0 nt
    v_mfma_f32_16x16x32_bf16 v[10:13], v[36:39], v[84:87], v[10:13]
    v_and_b32_dpp v36, v192, v6 row_newbcast:7 row_mask:0xf bank_mask:0xf
    v_and_b32_dpp v37, v192, v7 row_newbcast:7 row_mask:0xf bank_mask:0xf
    v_and_b32_dpp v38, v192, v8 row_newbcast:7 row_mask:0xf bank_mask:0xf
    v_and_b32_dpp v39, v192, v9 row_newbcast:7 row_mask:0xf bank_mask:0xf
    s_waitcnt vmcnt(5)
    s_add_u32 s34, s24, 151552
    buffer_load_dwordx4 v[116:119], v1, s[4:7], s34 offen offset:0 nt
    v_mfma_f32_16x16x32_bf16 v[10:13], v[32:35], v[88:91], v[10:13]
    v_and_b32_dpp v32, v192, v6 row_newbcast:8 row_mask:0xf bank_mask:0xf
    v_and_b32_dpp v33, v192, v7 row_newbcast:8 row_mask:0xf bank_mask:0xf
    v_and_b32_dpp v34, v192, v8 row_newbcast:8 row_mask:0xf bank_mask:0xf
    v_and_b32_dpp v35, v192, v9 row_newbcast:8 row_mask:0xf bank_mask:0xf
    s_waitcnt vmcnt(5)
    s_add_u32 s34, s24, 155648
    buffer_load_dwordx4 v[120:123], v1, s[4:7], s34 offen offset:0 nt
    v_mfma_f32_16x16x32_bf16 v[10:13], v[36:39], v[92:95], v[10:13]
    v_and_b32_dpp v36, v192, v6 row_newbcast:9 row_mask:0xf bank_mask:0xf
    v_and_b32_dpp v37, v192, v7 row_newbcast:9 row_mask:0xf bank_mask:0xf
    v_and_b32_dpp v38, v192, v8 row_newbcast:9 row_mask:0xf bank_mask:0xf
    v_and_b32_dpp v39, v192, v9 row_newbcast:9 row_mask:0xf bank_mask:0xf
    s_waitcnt vmcnt(5)
    s_add_u32 s34, s24, 159744
    buffer_load_dwordx4 v[124:127], v1, s[4:7], s34 offen offset:0 nt
    s_or_b32 s24, s24, 0x6ffff
    s_add_u32 s24, s24, 1
    s_bitcmp1_b32 s24, 21
    s_cselect_b32 s4, s44, s4
    s_cselect_b32 s5, s45, s5
    s_and_b32 s24, s24, 0x190000
    v_mfma_f32_16x16x32_bf16 v[10:13], v[32:35], v[96:99], v[10:13]
    v_and_b32_dpp v32, v192, v6 row_newbcast:10 row_mask:0xf bank_mask:0xf
    v_and_b32_dpp v33, v192, v7 row_newbcast:10 row_mask:0xf bank_mask:0xf
    v_and_b32_dpp v34, v192, v8 row_newbcast:10 row_mask:0xf bank_mask:0xf
    v_and_b32_dpp v35, v192, v9 row_newbcast:10 row_mask:0xf bank_mask:0xf
    s_waitcnt vmcnt(5)
    buffer_load_dwordx4 v[128:131], v1, s[8:11], s30 offen offset:0 nt
    v_mfma_f32_16x16x32_bf16 v[10:13], v[36:39], v[100:103], v[10:13]
    v_and_b32_dpp v36, v192, v6 row_newbcast:11 row_mask:0xf bank_mask:0xf
    v_and_b32_dpp v37, v192, v7 row_newbcast:11 row_mask:0xf bank_mask:0xf
    v_and_b32_dpp v38, v192, v8 row_newbcast:11 row_mask:0xf bank_mask:0xf
    v_and_b32_dpp v39, v192, v9 row_newbcast:11 row_mask:0xf bank_mask:0xf
    s_waitcnt vmcnt(5)
    s_add_u32 s34, s30, 4096
    buffer_load_dwordx4 v[132:135], v1, s[8:11], s34 offen offset:0 nt
    v_mfma_f32_16x16x32_bf16 v[10:13], v[32:35], v[104:107], v[10:13]
    v_and_b32_dpp v32, v192, v6 row_newbcast:12 row_mask:0xf bank_mask:0xf
    v_and_b32_dpp v33, v192, v7 row_newbcast:12 row_mask:0xf bank_mask:0xf
    v_and_b32_dpp v34, v192, v8 row_newbcast:12 row_mask:0xf bank_mask:0xf
    v_and_b32_dpp v35, v192, v9 row_newbcast:12 row_mask:0xf bank_mask:0xf
    s_waitcnt vmcnt(5)
    s_add_u32 s34, s30, 8192
    buffer_load_dwordx4 v[136:139], v1, s[8:11], s34 offen offset:0 nt
    buffer_load_dword v56, v55, s[20:23], s77 offen
    v_mfma_f32_16x16x32_bf16 v[10:13], v[36:39], v[108:111], v[10:13]
    v_and_b32_dpp v36, v192, v6 row_newbcast:13 row_mask:0xf bank_mask:0xf
    v_and_b32_dpp v37, v192, v7 row_newbcast:13 row_mask:0xf bank_mask:0xf
    v_and_b32_dpp v38, v192, v8 row_newbcast:13 row_mask:0xf bank_mask:0xf
    v_and_b32_dpp v39, v192, v9 row_newbcast:13 row_mask:0xf bank_mask:0xf
    s_waitcnt vmcnt(5)
    s_add_u32 s34, s30, 12288
    buffer_load_dwordx4 v[140:143], v1, s[8:11], s34 offen offset:0 nt
    v_mfma_f32_16x16x32_bf16 v[10:13], v[32:35], v[112:115], v[10:13]
    v_and_b32_dpp v32, v192, v6 row_newbcast:14 row_mask:0xf bank_mask:0xf
    v_and_b32_dpp v33, v192, v7 row_newbcast:14 row_mask:0xf bank_mask:0xf
    v_and_b32_dpp v34, v192, v8 row_newbcast:14 row_mask:0xf bank_mask:0xf
    v_and_b32_dpp v35, v192, v9 row_newbcast:14 row_mask:0xf bank_mask:0xf
    s_waitcnt vmcnt(5)
    s_add_u32 s34, s30, 16384
    buffer_load_dwordx4 v[144:147], v1, s[8:11], s34 offen offset:0 nt
    v_mfma_f32_16x16x32_bf16 v[10:13], v[36:39], v[116:119], v[10:13]
    v_and_b32_dpp v36, v192, v6 row_newbcast:15 row_mask:0xf bank_mask:0xf
    v_and_b32_dpp v37, v192, v7 row_newbcast:15 row_mask:0xf bank_mask:0xf
    v_and_b32_dpp v38, v192, v8 row_newbcast:15 row_mask:0xf bank_mask:0xf
    v_and_b32_dpp v39, v192, v9 row_newbcast:15 row_mask:0xf bank_mask:0xf
    s_waitcnt vmcnt(5)
    s_add_u32 s34, s30, 20480
    buffer_load_dwordx4 v[148:151], v1, s[8:11], s34 offen offset:0 nt
    v_mfma_f32_16x16x32_bf16 v[10:13], v[32:35], v[120:123], v[10:13]
    v_and_b32_dpp v32, v193, v6 row_newbcast:0 row_mask:0xf bank_mask:0xf
    v_and_b32_dpp v33, v193, v7 row_newbcast:0 row_mask:0xf bank_mask:0xf
    v_and_b32_dpp v34, v193, v8 row_newbcast:0 row_mask:0xf bank_mask:0xf
    v_and_b32_dpp v35, v193, v9 row_newbcast:0 row_mask:0xf bank_mask:0xf
    s_waitcnt vmcnt(5)
    s_add_u32 s34, s30, 24576
    buffer_load_dwordx4 v[152:155], v1, s[8:11], s34 offen offset:0 nt
    v_mfma_f32_16x16x32_bf16 v[10:13], v[36:39], v[124:127], v[10:13]
    v_and_b32_dpp v36, v193, v6 row_newbcast:1 row_mask:0xf bank_mask:0xf
    v_and_b32_dpp v37, v193, v7 row_newbcast:1 row_mask:0xf bank_mask:0xf
    v_and_b32_dpp v38, v193, v8 row_newbcast:1 row_mask:0xf bank_mask:0xf
    v_and_b32_dpp v39, v193, v9 row_newbcast:1 row_mask:0xf bank_mask:0xf
    s_waitcnt vmcnt(5)
    s_add_u32 s34, s30, 28672
    buffer_load_dwordx4 v[156:159], v1, s[8:11], s34 offen offset:0 nt
    v_mfma_f32_16x16x32_bf16 v[10:13], v[32:35], v[128:131], v[10:13]
    v_and_b32_dpp v32, v193, v6 row_newbcast:2 row_mask:0xf bank_mask:0xf
    v_and_b32_dpp v33, v193, v7 row_newbcast:2 row_mask:0xf bank_mask:0xf
    v_and_b32_dpp v34, v193, v8 row_newbcast:2 row_mask:0xf bank_mask:0xf
    v_and_b32_dpp v35, v193, v9 row_newbcast:2 row_mask:0xf bank_mask:0xf
    s_waitcnt vmcnt(5)
    s_add_u32 s34, s30, 131072
    buffer_load_dwordx4 v[160:163], v1, s[8:11], s34 offen offset:0 nt
    v_mfma_f32_16x16x32_bf16 v[10:13], v[36:39], v[132:135], v[10:13]
    v_and_b32_dpp v36, v193, v6 row_newbcast:3 row_mask:0xf bank_mask:0xf
    v_and_b32_dpp v37, v193, v7 row_newbcast:3 row_mask:0xf bank_mask:0xf
    v_and_b32_dpp v38, v193, v8 row_newbcast:3 row_mask:0xf bank_mask:0xf
    v_and_b32_dpp v39, v193, v9 row_newbcast:3 row_mask:0xf bank_mask:0xf
    s_waitcnt vmcnt(5)
    s_add_u32 s34, s30, 135168
    buffer_load_dwordx4 v[164:167], v1, s[8:11], s34 offen offset:0 nt
    v_mfma_f32_16x16x32_bf16 v[10:13], v[32:35], v[136:139], v[10:13]
    v_and_b32_dpp v32, v193, v6 row_newbcast:4 row_mask:0xf bank_mask:0xf
    v_and_b32_dpp v33, v193, v7 row_newbcast:4 row_mask:0xf bank_mask:0xf
    v_and_b32_dpp v34, v193, v8 row_newbcast:4 row_mask:0xf bank_mask:0xf
    v_and_b32_dpp v35, v193, v9 row_newbcast:4 row_mask:0xf bank_mask:0xf
    s_waitcnt vmcnt(5)
    s_add_u32 s34, s30, 139264
    buffer_load_dwordx4 v[168:171], v1, s[8:11], s34 offen offset:0 nt
    v_mfma_f32_16x16x32_bf16 v[10:13], v[36:39], v[140:143], v[10:13]
    v_and_b32_dpp v36, v193, v6 row_newbcast:5 row_mask:0xf bank_mask:0xf
    v_and_b32_dpp v37, v193, v7 row_newbcast:5 row_mask:0xf bank_mask:0xf
    v_and_b32_dpp v38, v193, v8 row_newbcast:5 row_mask:0xf bank_mask:0xf
    v_and_b32_dpp v39, v193, v9 row_newbcast:5 row_mask:0xf bank_mask:0xf
    s_waitcnt vmcnt(5)
    s_add_u32 s34, s30, 143360
    buffer_load_dwordx4 v[172:175], v1, s[8:11], s34 offen offset:0 nt
    v_mfma_f32_16x16x32_bf16 v[10:13], v[32:35], v[144:147], v[10:13]
    v_and_b32_dpp v32, v193, v6 row_newbcast:6 row_mask:0xf bank_mask:0xf
    v_and_b32_dpp v33, v193, v7 row_newbcast:6 row_mask:0xf bank_mask:0xf
    v_and_b32_dpp v34, v193, v8 row_newbcast:6 row_mask:0xf bank_mask:0xf
    v_and_b32_dpp v35, v193, v9 row_newbcast:6 row_mask:0xf bank_mask:0xf
    s_waitcnt vmcnt(5)
    s_add_u32 s34, s30, 147456
    buffer_load_dwordx4 v[176:179], v1, s[8:11], s34 offen offset:0 nt
    v_mfma_f32_16x16x32_bf16 v[10:13], v[36:39], v[148:151], v[10:13]
    v_and_b32_dpp v36, v193, v6 row_newbcast:7 row_mask:0xf bank_mask:0xf
    v_and_b32_dpp v37, v193, v7 row_newbcast:7 row_mask:0xf bank_mask:0xf
    v_and_b32_dpp v38, v193, v8 row_newbcast:7 row_mask:0xf bank_mask:0xf
    v_and_b32_dpp v39, v193, v9 row_newbcast:7 row_mask:0xf bank_mask:0xf
    s_waitcnt vmcnt(5)
    s_add_u32 s34, s30, 151552
    buffer_load_dwordx4 v[180:183], v1, s[8:11], s34 offen offset:0 nt
    v_mfma_f32_16x16x32_bf16 v[10:13], v[32:35], v[152:155], v[10:13]
    v_and_b32_dpp v32, v193, v6 row_newbcast:8 row_mask:0xf bank_mask:0xf
    v_and_b32_dpp v33, v193, v7 row_newbcast:8 row_mask:0xf bank_mask:0xf
    v_and_b32_dpp v34, v193, v8 row_newbcast:8 row_mask:0xf bank_mask:0xf
    v_and_b32_dpp v35, v193, v9 row_newbcast:8 row_mask:0xf bank_mask:0xf
    s_waitcnt vmcnt(5)
    s_add_u32 s34, s30, 155648
    buffer_load_dwordx4 v[184:187], v1, s[8:11], s34 offen offset:0 nt
    v_mfma_f32_16x16x32_bf16 v[10:13], v[36:39], v[156:159], v[10:13]
    v_and_b32_dpp v36, v193, v6 row_newbcast:9 row_mask:0xf bank_mask:0xf
    v_and_b32_dpp v37, v193, v7 row_newbcast:9 row_mask:0xf bank_mask:0xf
    v_and_b32_dpp v38, v193, v8 row_newbcast:9 row_mask:0xf bank_mask:0xf
    v_and_b32_dpp v39, v193, v9 row_newbcast:9 row_mask:0xf bank_mask:0xf
    s_waitcnt vmcnt(5)
    s_add_u32 s34, s30, 159744
    buffer_load_dwordx4 v[188:191], v1, s[8:11], s34 offen offset:0 nt
    s_or_b32 s30, s30, 0x6ffff
    s_add_u32 s30, s30, 1
    s_bitcmp1_b32 s30, 21
    s_cselect_b32 s8, s44, s8
    s_cselect_b32 s9, s45, s9
    s_and_b32 s30, s30, 0x190000
    s_or_b32 s30, s30, 0x40000
    v_mfma_f32_16x16x32_bf16 v[10:13], v[32:35], v[160:163], v[10:13]
    v_and_b32_dpp v32, v193, v6 row_newbcast:10 row_mask:0xf bank_mask:0xf
    v_and_b32_dpp v33, v193, v7 row_newbcast:10 row_mask:0xf bank_mask:0xf
    v_and_b32_dpp v34, v193, v8 row_newbcast:10 row_mask:0xf bank_mask:0xf
    v_and_b32_dpp v35, v193, v9 row_newbcast:10 row_mask:0xf bank_mask:0xf
    s_waitcnt vmcnt(5)
    buffer_load_dwordx4 v[64:67], v1, s[4:7], s24 offen offset:0 nt
    v_mfma_f32_16x16x32_bf16 v[10:13], v[36:39], v[164:167], v[10:13]
    v_and_b32_dpp v36, v193, v6 row_newbcast:11 row_mask:0xf bank_mask:0xf
    v_and_b32_dpp v37, v193, v7 row_newbcast:11 row_mask:0xf bank_mask:0xf
    v_and_b32_dpp v38, v193, v8 row_newbcast:11 row_mask:0xf bank_mask:0xf
    v_and_b32_dpp v39, v193, v9 row_newbcast:11 row_mask:0xf bank_mask:0xf
    s_waitcnt vmcnt(5)
    s_add_u32 s34, s24, 4096
    buffer_load_dwordx4 v[68:71], v1, s[4:7], s34 offen offset:0 nt
    v_mfma_f32_16x16x32_bf16 v[10:13], v[32:35], v[168:171], v[10:13]
    v_and_b32_dpp v32, v193, v6 row_newbcast:12 row_mask:0xf bank_mask:0xf
    v_and_b32_dpp v33, v193, v7 row_newbcast:12 row_mask:0xf bank_mask:0xf
    v_and_b32_dpp v34, v193, v8 row_newbcast:12 row_mask:0xf bank_mask:0xf
    v_and_b32_dpp v35, v193, v9 row_newbcast:12 row_mask:0xf bank_mask:0xf
    s_waitcnt vmcnt(5)
    s_add_u32 s34, s24, 8192
    buffer_load_dwordx4 v[72:75], v1, s[4:7], s34 offen offset:0 nt
    v_mfma_f32_16x16x32_bf16 v[10:13], v[36:39], v[172:175], v[10:13]
    v_and_b32_dpp v36, v193, v6 row_newbcast:13 row_mask:0xf bank_mask:0xf
    v_and_b32_dpp v37, v193, v7 row_newbcast:13 row_mask:0xf bank_mask:0xf
    v_and_b32_dpp v38, v193, v8 row_newbcast:13 row_mask:0xf bank_mask:0xf
    v_and_b32_dpp v39, v193, v9 row_newbcast:13 row_mask:0xf bank_mask:0xf
    s_waitcnt vmcnt(5)
    s_add_u32 s34, s24, 12288
    buffer_load_dwordx4 v[76:79], v1, s[4:7], s34 offen offset:0 nt
    v_mfma_f32_16x16x32_bf16 v[10:13], v[32:35], v[176:179], v[10:13]
    v_and_b32_dpp v32, v193, v6 row_newbcast:14 row_mask:0xf bank_mask:0xf
    v_and_b32_dpp v33, v193, v7 row_newbcast:14 row_mask:0xf bank_mask:0xf
    v_and_b32_dpp v34, v193, v8 row_newbcast:14 row_mask:0xf bank_mask:0xf
    v_and_b32_dpp v35, v193, v9 row_newbcast:14 row_mask:0xf bank_mask:0xf
    s_waitcnt vmcnt(5)
    s_add_u32 s34, s24, 16384
    buffer_load_dwordx4 v[80:83], v1, s[4:7], s34 offen offset:0 nt
    v_sub_u32 v57, v56, v58
    v_mov_b32 v58, v56
    v_add_u32 v56, v56, v57
    v_subrev_u32 v56, s68, v56
    v_and_b32 v57, 0x3ff, v56
    v_cmp_eq_u32 s[70:71], 0, v57
    v_cmp_gt_i32 vcc, 0xffff6000, v56
    s_and_b32 s72, vcc_lo, s70
    v_cmp_lt_i32 vcc, 0xf000, v56
    s_bcnt1_i32_b32 s72, s72
    s_orn2_b32 s73, vcc_lo, s70
    s_bcnt1_i32_b32 s73, s73
    s_cmp_gt_u32 s73, 16
    s_cselect_b32 s78, 1, 0
    s_cmp_ge_u32 s72, 16
    s_cselect_b32 s78, 2, s78
    s_cmp_ge_u32 s33, 12
    s_cselect_b32 s78, 0, s78
    v_mfma_f32_16x16x32_bf16 v[10:13], v[36:39], v[180:183], v[10:13]
    v_and_b32_dpp v36, v193, v6 row_newbcast:15 row_mask:0xf bank_mask:0xf
    v_and_b32_dpp v37, v193, v7 row_newbcast:15 row_mask:0xf bank_mask:0xf
    v_and_b32_dpp v38, v193, v8 row_newbcast:15 row_mask:0xf bank_mask:0xf
    v_and_b32_dpp v39, v193, v9 row_newbcast:15 row_mask:0xf bank_mask:0xf
    s_waitcnt vmcnt(5)
    s_add_u32 s34, s24, 20480
    buffer_load_dwordx4 v[84:87], v1, s[4:7], s34 offen offset:0 nt
    v_mfma_f32_16x16x32_bf16 v[10:13], v[32:35], v[184:187], v[10:13]
    s_waitcnt vmcnt(5)
    s_add_u32 s34, s24, 24576
    buffer_load_dwordx4 v[88:91], v1, s[4:7], s34 offen offset:0 nt
    s_nop 0
    v_mfma_f32_16x16x32_bf16 v[10:13], v[36:39], v[188:191], v[10:13]
    v_mov_b32 v192, v194
    v_mov_b32 v193, v195
    v_mov_b32 v194, v196
    v_mov_b32 v195, v197
    v_mov_b32 v196, v198
    v_mov_b32 v197, v199
    v_mov_b32 v198, v200
    v_mov_b32 v199, v201
    v_mov_b32 v200, v202
    v_mov_b32 v201, v203
    v_mov_b32 v202, v204
    v_mov_b32 v203, v205
    v_mov_b32 v204, v206
    v_mov_b32 v205, v207
    s_sub_u32 s33, s33, 1
    s_cmp_lg_u32 s33, 0
    s_cbranch_scc1 L_loop2
    s_branch L_last
L_v1:
    v_and_b32_dpp v32, v192, v6 row_newbcast:0 row_mask:0xf bank_mask:0xf
    v_and_b32_dpp v33, v192, v7 row_newbcast:0 row_mask:0xf bank_mask:0xf
    v_and_b32_dpp v34, v192, v8 row_newbcast:0 row_mask:0xf bank_mask:0xf
    v_and_b32_dpp v35, v192, v9 row_newbcast:0 row_mask:0xf bank_mask:0xf
    v_and_b32_dpp v36, v192, v6 row_newbcast:1 row_mask:0xf bank_mask:0xf
    v_and_b32_dpp v37, v192, v7 row_newbcast:1 row_mask:0xf bank_mask:0xf
    v_and_b32_dpp v38, v192, v8 row_newbcast:1 row_mask:0xf bank_mask:0xf
    v_and_b32_dpp v39, v192, v9 row_newbcast:1 row_mask:0xf bank_mask:0xf
    s_waitcnt vmcnt(4)
    s_add_u32 s34, s24, 28672
    buffer_load_dwordx4 v[92:95], v1, s[4:7], s34 offen offset:0 nt
    v_mfma_f32_16x16x32_bf16 v[10:13], v[32:35], v[64:67], v[10:13]
    v_and_b32_dpp v32, v192, v6 row_newbcast:2 row_mask:0xf bank_mask:0xf
    v_and_b32_dpp v33, v192, v7 row_newbcast:2 row_mask:0xf bank_mask:0xf
    v_and_b32_dpp v34, v192, v8 row_newbcast:2 row_mask:0xf bank_mask:0xf
    v_and_b32_dpp v35, v192, v9 row_newbcast:2 row_mask:0xf bank_mask:0xf
    s_waitcnt vmcnt(4)
    s_add_u32 s34, s24, 131072
    buffer_load_dwordx4 v[96:99], v1, s[4:7], s34 offen offset:0 nt
    v_mfma_f32_16x16x32_bf16 v[10:13], v[36:39], v[68:71], v[10:13]
    v_and_b32_dpp v36, v192, v6 row_newbcast:3 row_mask:0xf bank_mask:0xf
    v_and_b32_dpp v37, v192, v7 row_newbcast:3 row_mask:0xf bank_mask:0xf
    v_and_b32_dpp v38, v192, v8 row_newbcast:3 row_mask:0xf bank_mask:0xf
    v_and_b32_dpp v39, v192, v9 row_newbcast:3 row_mask:0xf bank_mask:0xf
    s_waitcnt vmcnt(4)
    s_add_u32 s34, s24, 135168
    buffer_load_dwordx4 v[100:103], v1, s[4:7], s34 offen offset:0 nt
    s_waitcnt lgkmcnt(0)
    s_mov_b32 s79, s68
    s_lshl_b32 s68, s66, 10
    s_or_b32 s68, s68, s65
    s_mov_b32 s77, s69
    s_sub_u32 s69, s69, 4096
    v_mov_b32 v53, s68
    buffer_store_dword v53, v54, s[20:23], s69 offen sc1
    v_mfma_f32_16x16x32_bf16 v[10:13], v[32:35], v[72:75], v[10:13]
    v_and_b32_dpp v32, v192, v6 row_newbcast:4 row_mask:0xf bank_mask:0xf
    v_and_b32_dpp v33, v192, v7 row_newbcast:4 row_mask:0xf bank_mask:0xf
    v_and_b32_dpp v34, v192, v8 row_newbcast:4 row_mask:0xf bank_mask:0xf
    v_and_b32_dpp v35, v192, v9 row_newbcast:4 row_mask:0xf bank_mask:0xf
    s_waitcnt vmcnt(4)
    s_add_u32 s34, s24, 139264
    buffer_load_dwordx4 v[104:107], v1, s[4:7], s34 offen offset:0 nt
    v_mfma_f32_16x16x32_bf16 v[10:13], v[36:39], v[76:79], v[10:13]
    v_and_b32_dpp v36, v192, v6 row_newbcast:5 row_mask:0xf bank_mask:0xf
    v_and_b32_dpp v37, v192, v7 row_newbcast:5 row_mask:0xf bank_mask:0xf
    v_and_b32_dpp v38, v192, v8 row_newbcast:5 row_mask:0xf bank_mask:0xf
    v_and_b32_dpp v39, v192, v9 row_newbcast:5 row_mask:0xf bank_mask:0xf
    s_waitcnt vmcnt(4)
    s_add_u32 s34, s24, 143360
    buffer_load_dwordx4 v[108:111], v1, s[4:7], s34 offen offset:0 nt
    v_mfma_f32_16x16x32_bf16 v[10:13], v[32:35], v[80:83], v[10:13]
    v_and_b32_dpp v32, v192, v6 row_newbcast:6 row_mask:0xf bank_mask:0xf
    v_and_b32_dpp v33, v192, v7 row_newbcast:6 row_mask:0xf bank_mask:0xf
    v_and_b32_dpp v34, v192, v8 row_newbcast:6 row_mask:0xf bank_mask:0xf
    v_and_b32_dpp v35, v192, v9 row_newbcast:6 row_mask:0xf bank_mask:0xf
    s_waitcnt vmcnt(4)
    s_add_u32 s34, s24, 147456
    buffer_load_dwordx4 v[112:115], v1, s[4:7], s34 offen offset:0 nt
    v_mfma_f32_16x16x32_bf16 v[10:13], v[36:39], v[84:87], v[10:13]
    v_and_b32_dpp v36, v192, v6 row_newbcast:7 row_mask:0xf bank_mask:0xf
    v_and_b32_dpp v37, v192, v7 row_newbcast:7 row_mask:0xf bank_mask:0xf
    v_and_b32_dpp v38, v192, v8 row_newbcast:7 row_mask:0xf bank_mask:0xf
    v_and_b32_dpp v39, v192, v9 row_newbcast:7 row_mask:0xf bank_mask:0xf
    s_waitcnt vmcnt(4)
    s_add_u32 s34, s24, 151552
    buffer_load_dwordx4 v[116:119], v1, s[4:7], s34 offen offset:0 nt
    v_mfma_f32_16x16x32_bf16 v[10:13], v[32:35], v[88:91], v[10:13]
    v_and_b32_dpp v32, v192, v6 row_newbcast:8 row_mask:0xf bank_mask:0xf
    v_and_b32_dpp v33, v192, v7 row_newbcast:8 row_mask:0xf bank_mask:0xf
    v_and_b32_dpp v34, v192, v8 row_newbcast:8 row_mask:0xf bank_mask:0xf
    v_and_b32_dpp v35, v192, v9 row_newbcast:8 row_mask:0xf bank_mask:0xf
    s_waitcnt vmcnt(4)
    s_add_u32 s34, s24, 155648
    buffer_load_dwordx4 v[120:123], v1, s[4:7], s34 offen offset:0 nt
    v_mfma_f32_16x16x32_bf16 v[10:13], v[36:39], v[92:95], v[10:13]
    v_and_b32_dpp v36, v192, v6 row_newbcast:9 row_mask:0xf bank_mask:0xf
    v_and_b32_dpp v37, v192, v7 row_newbcast:9 row_mask:0xf bank_mask:0xf
    v_and_b32_dpp v38, v192, v8 row_newbcast:9 row_mask:0xf bank_mask:0xf
    v_and_b32_dpp v39, v192, v9 row_newbcast:9 row_mask:0xf bank_mask:0xf
    s_waitcnt vmcnt(4)
    s_add_u32 s34, s24, 159744
    buffer_load_dwordx4 v[124:127], v1, s[4:7], s34 offen offset:0 nt
    s_or_b32 s24, s24, 0x6ffff
    s_add_u32 s24, s24, 1
    s_bitcmp1_b32 s24, 21
    s_cselect_b32 s4, s44, s4
    s_cselect_b32 s5, s45, s5
    s_and_b32 s24, s24, 0x190000
    v_mfma_f32_16x16x32_bf16 v[10:13], v[32:35], v[96:99], v[10:13]
    v_and_b32_dpp v32, v192, v6 row_newbcast:10 row_mask:0xf bank_mask:0xf
    v_and_b32_dpp v33, v192, v7 row_newbcast:10 row_mask:0xf bank_mask:0xf
    v_and_b32_dpp v34, v192, v8 row_newbcast:10 row_mask:0xf bank_mask:0xf
    v_and_b32_dpp v35, v192, v9 row_newbcast:10 row_mask:0xf bank_mask:0xf
    s_waitcnt vmcnt(4)
    buffer_load_dwordx4 v[128:131], v1, s[8:11], s30 offen offset:0 nt
    v_mfma_f32_16x16x32_bf16 v[10:13], v[36:39], v[100:103], v[10:13]
    v_and_b32_dpp v36, v192, v6 row_newbcast:11 row_mask:0xf bank_mask:0xf
    v_and_b32_dpp v37, v192, v7 row_newbcast:11 row_mask:0xf bank_mask:0xf
    v_and_b32_dpp v38, v192, v8 row_newbcast:11 row_mask:0xf bank_mask:0xf
    v_and_b32_dpp v39, v192, v9 row_newbcast:11 row_mask:0xf bank_mask:0xf
    s_waitcnt vmcnt(4)
    s_add_u32 s34, s30, 4096
    buffer_load_dwordx4 v[132:135], v1, s[8:11], s34 offen offset:0 nt
    v_mfma_f32_16x16x32_bf16 v[10:13], v[32:35], v[104:107], v[10:13]
    v_and_b32_dpp v32, v192, v6 row_newbcast:12 row_mask:0xf bank_mask:0xf
    v_and_b32_dpp v33, v192, v7 row_newbcast:12 row_mask:0xf bank_mask:0xf
    v_and_b32_dpp v34, v192, v8 row_newbcast:12 row_mask:0xf bank_mask:0xf
    v_and_b32_dpp v35, v192, v9 row_newbcast:12 row_mask:0xf bank_mask:0xf
    s_waitcnt vmcnt(4)
    s_add_u32 s34, s30, 8192
    buffer_load_dwordx4 v[136:139], v1, s[8:11], s34 offen offset:0 nt
    buffer_load_dword v56, v55, s[20:23], s77 offen
    v_mfma_f32_16x16x32_bf16 v[10:13], v[36:39], v[108:111], v[10:13]
    v_and_b32_dpp v36, v192, v6 row_newbcast:13 row_mask:0xf bank_mask:0xf
    v_and_b32_dpp v37, v192, v7 row_newbcast:13 row_mask:0xf bank_mask:0xf
    v_and_b32_dpp v38, v192, v8 row_newbcast:13 row_mask:0xf bank_mask:0xf
    v_and_b32_dpp v39, v192, v9 row_newbcast:13 row_mask:0xf bank_mask:0xf
    s_waitcnt vmcnt(4)
    s_add_u32 s34, s30, 12288
    buffer_load_dwordx4 v[140:143], v1, s[8:11], s34 offen offset:0 nt
    v_mfma_f32_16x16x32_bf16 v[10:13], v[32:35], v[112:115], v[10:13]
    v_and_b32_dpp v32, v192, v6 row_newbcast:14 row_mask:0xf bank_mask:0xf
    v_and_b32_dpp v33, v192, v7 row_newbcast:14 row_mask:0xf bank_mask:0xf
    v_and_b32_dpp v34, v192, v8 row_newbcast:14 row_mask:0xf bank_mask:0xf
    v_and_b32_dpp v35, v192, v9 row_newbcast:14 row_mask:0xf bank_mask:0xf
    s_waitcnt vmcnt(4)
    s_add_u32 s34, s30, 16384
    buffer_load_dwordx4 v[144:147], v1, s[8:11], s34 offen offset:0 nt
    v_mfma_f32_16x16x32_bf16 v[10:13], v[36:39], v[116:119], v[10:13]
    v_and_b32_dpp v36, v192, v6 row_newbcast:15 row_mask:0xf bank_mask:0xf
    v_and_b32_dpp v37, v192, v7 row_newbcast:15 row_mask:0xf bank_mask:0xf
    v_and_b32_dpp v38, v192, v8 row_newbcast:15 row_mask:0xf bank_mask:0xf
    v_and_b32_dpp v39, v192, v9 row_newbcast:15 row_mask:0xf bank_mask:0xf
    s_waitcnt vmcnt(4)
    s_add_u32 s34, s30, 20480
    buffer_load_dwordx4 v[148:151], v1, s[8:11], s34 offen offset:0 nt
    v_mfma_f32_16x16x32_bf16 v[10:13], v[32:35], v[120:123], v[10:13]
    v_and_b32_dpp v32, v193, v6 row_newbcast:0 row_mask:0xf bank_mask:0xf
    v_and_b32_dpp v33, v193, v7 row_newbcast:0 row_mask:0xf bank_mask:0xf
    v_and_b32_dpp v34, v193, v8 row_newbcast:0 row_mask:0xf bank_mask:0xf
    v_and_b32_dpp v35, v193, v9 row_newbcast:0 row_mask:0xf bank_mask:0xf
    s_waitcnt vmcnt(4)
    s_add_u32 s34, s30, 24576
    buffer_load_dwordx4 v[152:155], v1, s[8:11], s34 offen offset:0 nt
    v_mfma_f32_16x16x32_bf16 v[10:13], v[36:39], v[124:127], v[10:13]
    v_and_b32_dpp v36, v193, v6 row_newbcast:1 row_mask:0xf bank_mask:0xf
    v_and_b32_dpp v37, v193, v7 row_newbcast:1 row_mask:0xf bank_mask:0xf
    v_and_b32_dpp v38, v193, v8 row_newbcast:1 row_mask:0xf bank_mask:0xf
    v_and_b32_dpp v39, v193, v9 row_newbcast:1 row_mask:0xf bank_mask:0xf
    s_waitcnt vmcnt(4)
    s_add_u32 s34, s30, 28672
    buffer_load_dwordx4 v[156:159], v1, s[8:11], s34 offen offset:0 nt
    v_mfma_f32_16x16x32_bf16 v[10:13], v[32:35], v[128:131], v[10:13]
    v_and_b32_dpp v32, v193, v6 row_newbcast:2 row_mask:0xf bank_mask:0xf
    v_and_b32_dpp v33, v193, v7 row_newbcast:2 row_mask:0xf bank_mask:0xf
    v_and_b32_dpp v34, v193, v8 row_newbcast:2 row_mask:0xf bank_mask:0xf
    v_and_b32_dpp v35, v193, v9 row_newbcast:2 row_mask:0xf bank_mask:0xf
    s_waitcnt vmcnt(4)
    s_add_u32 s34, s30, 131072
    buffer_load_dwordx4 v[160:163], v1, s[8:11], s34 offen offset:0 nt
    v_mfma_f32_16x16x32_bf16 v[10:13], v[36:39], v[132:135], v[10:13]
    v_and_b32_dpp v36, v193, v6 row_newbcast:3 row_mask:0xf bank_mask:0xf
    v_and_b32_dpp v37, v193, v7 row_newbcast:3 row_mask:0xf bank_mask:0xf
    v_and_b32_dpp v38, v193, v8 row_newbcast:3 row_mask:0xf bank_mask:0xf
    v_and_b32_dpp v39, v193, v9 row_newbcast:3 row_mask:0xf bank_mask:0xf
    s_waitcnt vmcnt(4)
    s_add_u32 s34, s30, 135168
    buffer_load_dwordx4 v[164:167], v1, s[8:11], s34 offen offset:0 nt
    v_mfma_f32_16x16x32_bf16 v[10:13], v[32:35], v[136:139], v[10:13]
    v_and_b32_dpp v32, v193, v6 row_newbcast:4 row_mask:0xf bank_mask:0xf
    v_and_b32_dpp v33, v193, v7 row_newbcast:4 row_mask:0xf bank_mask:0xf
    v_and_b32_dpp v34, v193, v8 row_newbcast:4 row_mask:0xf bank_mask:0xf
    v_and_b32_dpp v35, v193, v9 row_newbcast:4 row_mask:0xf bank_mask:0xf
    s_waitcnt vmcnt(4)
    s_add_u32 s34, s30, 139264
    buffer_load_dwordx4 v[168:171], v1, s[8:11], s34 offen offset:0 nt
    v_mfma_f32_16x16x32_bf16 v[10:13], v[36:39], v[140:143], v[10:13]
    v_and_b32_dpp v36, v193, v6 row_newbcast:5 row_mask:0xf bank_mask:0xf
    v_and_b32_dpp v37, v193, v7 row_newbcast:5 row_mask:0xf bank_mask:0xf
    v_and_b32_dpp v38, v193, v8 row_newbcast:5 row_mask:0xf bank_mask:0xf
    v_and_b32_dpp v39, v193, v9 row_newbcast:5 row_mask:0xf bank_mask:0xf
    s_waitcnt vmcnt(4)
    s_add_u32 s34, s30, 143360
    buffer_load_dwordx4 v[172:175], v1, s[8:11], s34 offen offset:0 nt
    v_mfma_f32_16x16x32_bf16 v[10:13], v[32:35], v[144:147], v[10:13]
    v_and_b32_dpp v32, v193, v6 row_newbcast:6 row_mask:0xf bank_mask:0xf
    v_and_b32_dpp v33, v193, v7 row_newbcast:6 row_mask:0xf bank_mask:0xf
    v_and_b32_dpp v34, v193, v8 row_newbcast:6 row_mask:0xf bank_mask:0xf
    v_and_b32_dpp v35, v193, v9 row_newbcast:6 row_mask:0xf bank_mask:0xf
    s_waitcnt vmcnt(4)
    s_add_u32 s34, s30, 147456
    buffer_load_dwordx4 v[176:179], v1, s[8:11], s34 offen offset:0 nt
    v_mfma_f32_16x16x32_bf16 v[10:13], v[36:39], v[148:151], v[10:13]
    v_and_b32_dpp v36, v193, v6 row_newbcast:7 row_mask:0xf bank_mask:0xf
    v_and_b32_dpp v37, v193, v7 row_newbcast:7 row_mask:0xf bank_mask:0xf
    v_and_b32_dpp v38, v193, v8 row_newbcast:7 row_mask:0xf bank_mask:0xf
    v_and_b32_dpp v39, v193, v9 row_newbcast:7 row_mask:0xf bank_mask:0xf
    s_waitcnt vmcnt(4)
    s_add_u32 s34, s30, 151552
    buffer_load_dwordx4 v[180:183], v1, s[8:11], s34 offen offset:0 nt
    v_mfma_f32_16x16x32_bf16 v[10:13], v[32:35], v[152:155], v[10:13]
    v_and_b32_dpp v32, v193, v6 row_newbcast:8 row_mask:0xf bank_mask:0xf
    v_and_b32_dpp v33, v193, v7 row_newbcast:8 row_mask:0xf bank_mask:0xf
    v_and_b32_dpp v34, v193, v8 row_newbcast:8 row_mask:0xf bank_mask:0xf
    v_and_b32_dpp v35, v193, v9 row_newbcast:8 row_mask:0xf bank_mask:0xf
    s_waitcnt vmcnt(4)
    s_add_u32 s34, s30, 155648
    buffer_load_dwordx4 v[184:187], v1, s[8:11], s34 offen offset:0 nt
    v_mfma_f32_16x16x32_bf16 v[10:13], v[36:39], v[156:159], v[10:13]
    v_and_b32_dpp v36, v193, v6 row_newbcast:9 row_mask:0xf bank_mask:0xf
    v_and_b32_dpp v37, v193, v7 row_newbcast:9 row_mask:0xf bank_mask:0xf
    v_and_b32_dpp v38, v193, v8 row_newbcast:9 row_mask:0xf bank_mask:0xf
    v_and_b32_dpp v39, v193, v9 row_newbcast:9 row_mask:0xf bank_mask:0xf
    s_waitcnt vmcnt(4)
    s_add_u32 s34, s30, 159744
    buffer_load_dwordx4 v[188:191], v1, s[8:11], s34 offen offset:0 nt
    s_or_b32 s30, s30, 0x6ffff
    s_add_u32 s30, s30, 1
    s_bitcmp1_b32 s30, 21
    s_cselect_b32 s8, s44, s8
    s_cselect_b32 s9, s45, s9
    s_and_b32 s30, s30, 0x190000
    s_or_b32 s30, s30, 0x40000
    v_mfma_f32_16x16x32_bf16 v[10:13], v[32:35], v[160:163], v[10:13]
    v_and_b32_dpp v32, v193, v6 row_newbcast:10 row_mask:0xf bank_mask:0xf
    v_and_b32_dpp v33, v193, v7 row_newbcast:10 row_mask:0xf bank_mask:0xf
    v_and_b32_dpp v34, v193, v8 row_newbcast:10 row_mask:0xf bank_mask:0xf
    v_and_b32_dpp v35, v193, v9 row_newbcast:10 row_mask:0xf bank_mask:0xf
    s_waitcnt vmcnt(4)
    buffer_load_dwordx4 v[64:67], v1, s[4:7], s24 offen offset:0 nt
    v_mfma_f32_16x16x32_bf16 v[10:13], v[36:39], v[164:167], v[10:13]
    v_and_b32_dpp v36, v193, v6 row_newbcast:11 row_mask:0xf bank_mask:0xf
    v_and_b32_dpp v37, v193, v7 row_newbcast:11 row_mask:0xf bank_mask:0xf
    v_and_b32_dpp v38, v193, v8 row_newbcast:11 row_mask:0xf bank_mask:0xf
    v_and_b32_dpp v39, v193, v9 row_newbcast:11 row_mask:0xf bank_mask:0xf
    s_waitcnt vmcnt(4)
    s_add_u32 s34, s24, 4096
    buffer_load_dwordx4 v[68:71], v1, s[4:7], s34 offen offset:0 nt
    v_mfma_f32_16x16x32_bf16 v[10:13], v[32:35], v[168:171], v[10:13]
    v_and_b32_dpp v32, v193, v6 row_newbcast:12 row_mask:0xf bank_mask:0xf
    v_and_b32_dpp v33, v193, v7 row_newbcast:12 row_mask:0xf bank_mask:0xf
    v_and_b32_dpp v34, v193, v8 row_newbcast:12 row_mask:0xf bank_mask:0xf
    v_and_b32_dpp v35, v193, v9 row_newbcast:12 row_mask:0xf bank_mask:0xf
    s_waitcnt vmcnt(4)
    s_add_u32 s34, s24, 8192
    buffer_load_dwordx4 v[72:75], v1, s[4:7], s34 offen offset:0 nt
    v_mfma_f32_16x16x32_bf16 v[10:13], v[36:39], v[172:175], v[10:13]
    v_and_b32_dpp v36, v193, v6 row_newbcast:13 row_mask:0xf bank_mask:0xf
    v_and_b32_dpp v37, v193, v7 row_newbcast:13 row_mask:0xf bank_mask:0xf
    v_and_b32_dpp v38, v193, v8 row_newbcast:13 row_mask:0xf bank_mask:0xf
    v_and_b32_dpp v39, v193, v9 row_newbcast:13 row_mask:0xf bank_mask:0xf
    s_waitcnt vmcnt(4)
    s_add_u32 s34, s24, 12288
    buffer_load_dwordx4 v[76:79], v1, s[4:7], s34 offen offset:0 nt
    v_mfma_f32_16x16x32_bf16 v[10:13], v[32:35], v[176:179], v[10:13]
    v_and_b32_dpp v32, v193, v6 row_newbcast:14 row_mask:0xf bank_mask:0xf
    v_and_b32_dpp v33, v193, v7 row_newbcast:14 row_mask:0xf bank_mask:0xf
    v_and_b32_dpp v34, v193, v8 row_newbcast:14 row_mask:0xf bank_mask:0xf
    v_and_b32_dpp v35, v193, v9 row_newbcast:14 row_mask:0xf bank_mask:0xf
    s_waitcnt vmcnt(4)
    s_add_u32 s34, s24, 16384
    buffer_load_dwordx4 v[80:83], v1, s[4:7], s34 offen offset:0 nt
    v_sub_u32 v57, v56, v58
    v_mov_b32 v58, v56
    v_add_u32 v56, v56, v57
    v_subrev_u32 v56, s68, v56
    v_and_b32 v57, 0x3ff, v56
    v_cmp_eq_u32 s[70:71], 0, v57
    v_cmp_gt_i32 vcc, 0xffff6000, v56
    s_and_b32 s72, vcc_lo, s70
    v_cmp_lt_i32 vcc, 0xf000, v56
    s_bcnt1_i32_b32 s72, s72
    s_orn2_b32 s73, vcc_lo, s70
    s_bcnt1_i32_b32 s73, s73
    s_cmp_gt_u32 s73, 16
    s_cselect_b32 s78, 1, 0
    s_cmp_ge_u32 s72, 16
    s_cselect_b32 s78, 2, s78
    s_cmp_ge_u32 s33, 12
    s_cselect_b32 s78, 0, s78
    v_mfma_f32_16x16x32_bf16 v[10:13], v[36:39], v[180:183], v[10:13]
    v_and_b32_dpp v36, v193, v6 row_newbcast:15 row_mask:0xf bank_mask:0xf
    v_and_b32_dpp v37, v193, v7 row_newbcast:15 row_mask:0xf bank_mask:0xf
    v_and_b32_dpp v38, v193, v8 row_newbcast:15 row_mask:0xf bank_mask:0xf
    v_and_b32_dpp v39, v193, v9 row_newbcast:15 row_mask:0xf bank_mask:0xf
    s_waitcnt vmcnt(4)
    s_add_u32 s34, s24, 20480
    buffer_load_dwordx4 v[84:87], v1, s[4:7], s34 offen offset:0 nt
    v_mfma_f32_16x16x32_bf16 v[10:13], v[32:35], v[184:187], v[10:13]
    s_waitcnt vmcnt(4)
    s_add_u32 s34, s24, 24576
    buffer_load_dwordx4 v[88:91], v1, s[4:7], s34 offen offset:0 nt
    s_nop 0
    v_mfma_f32_16x16x32_bf16 v[10:13], v[36:39], v[188:191], v[10:13]
    v_mov_b32 v192, v194
    v_mov_b32 v193, v195
    v_mov_b32 v194, v196
    v_mov_b32 v195, v197
    v_mov_b32 v196, v198
    v_mov_b32 v197, v199
    v_mov_b32 v198, v200
    v_mov_b32 v199, v201
    v_mov_b32 v200, v202
    v_mov_b32 v201, v203
    v_mov_b32 v202, v204
    v_mov_b32 v203, v205
    v_mov_b32 v204, v206
    v_mov_b32 v205, v207
    s_sub_u32 s33, s33, 1
    s_cmp_lg_u32 s33, 0
    s_cbranch_scc1 L_loop2
    s_branch L_last
L_v2:
    v_and_b32_dpp v32, v192, v6 row_newbcast:0 row_mask:0xf bank_mask:0xf
    v_and_b32_dpp v33, v192, v7 row_newbcast:0 row_mask:0xf bank_mask:0xf
    v_and_b32_dpp v34, v192, v8 row_newbcast:0 row_mask:0xf bank_mask:0xf
    v_and_b32_dpp v35, v192, v9 row_newbcast:0 row_mask:0xf bank_mask:0xf
    v_and_b32_dpp v36, v192, v6 row_newbcast:1 row_mask:0xf bank_mask:0xf
    v_and_b32_dpp v37, v192, v7 row_newbcast:1 row_mask:0xf bank_mask:0xf
    v_and_b32_dpp v38, v192, v8 row_newbcast:1 row_mask:0xf bank_mask:0xf
    v_and_b32_dpp v39, v192, v9 row_newbcast:1 row_mask:0xf bank_mask:0xf
    s_waitcnt vmcnt(6)
    s_add_u32 s34, s24, 28672
    buffer_load_dwordx4 v[92:95], v1, s[4:7], s34 offen offset:0 nt
    v_mfma_f32_16x16x32_bf16 v[10:13], v[32:35], v[64:67], v[10:13]
    v_and_b32_dpp v32, v192, v6 row_newbcast:2 row_mask:0xf bank_mask:0xf
    v_and_b32_dpp v33, v192, v7 row_newbcast:2 row_mask:0xf bank_mask:0xf
    v_and_b32_dpp v34, v192, v8 row_newbcast:2 row_mask:0xf bank_mask:0xf
    v_and_b32_dpp v35, v192, v9 row_newbcast:2 row_mask:0xf bank_mask:0xf
    s_waitcnt vmcnt(6)
    s_add_u32 s34, s24, 131072
    buffer_load_dwordx4 v[96:99], v1, s[4:7], s34 offen offset:0 nt
    v_mfma_f32_16x16x32_bf16 v[10:13], v[36:39], v[68:71], v[10:13]
    v_and_b32_dpp v36, v192, v6 row_newbcast:3 row_mask:0xf bank_mask:0xf
    v_and_b32_dpp v37, v192, v7 row_newbcast:3 row_mask:0xf bank_mask:0xf
    v_and_b32_dpp v38, v192, v8 row_newbcast:3 row_mask:0xf bank_mask:0xf
    v_and_b32_dpp v39, v192, v9 row_newbcast:3 row_mask:0xf bank_mask:0xf
    s_waitcnt vmcnt(6)
    s_add_u32 s34, s24, 135168
    buffer_load_dwordx4 v[100:103], v1, s[4:7], s34 offen offset:0 nt
    s_waitcnt lgkmcnt(0)
    s_mov_b32 s79, s68
    s_lshl_b32 s68, s66, 10
    s_or_b32 s68, s68, s65
    s_mov_b32 s77, s69
    s_sub_u32 s69, s69, 4096
    v_mov_b32 v53, s68
    buffer_store_dword v53, v54, s[20:23], s69 offen sc1
    v_mfma_f32_16x16x32_bf16 v[10:13], v[32:35], v[72:75], v[10:13]
    v_and_b32_dpp v32, v192, v6 row_newbcast:4 row_mask:0xf bank_mask:0xf
    v_and_b32_dpp v33, v192, v7 row_newbcast:4 row_mask:0xf bank_mask:0xf
    v_and_b32_dpp v34, v192, v8 row_newbcast:4 row_mask:0xf bank_mask:0xf
    v_and_b32_dpp v35, v192, v9 row_newbcast:4 row_mask:0xf bank_mask:0xf
    s_waitcnt vmcnt(6)
    s_add_u32 s34, s24, 139264
    buffer_load_dwordx4 v[104:107], v1, s[4:7], s34 offen offset:0 nt
    v_mfma_f32_16x16x32_bf16 v[10:13], v[36:39], v[76:79], v[10:13]
    v_and_b32_dpp v36, v192, v6 row_newbcast:5 row_mask:0xf bank_mask:0xf
    v_and_b32_dpp v37, v192, v7 row_newbcast:5 row_mask:0xf bank_mask:0xf
    v_and_b32_dpp v38, v192, v8 row_newbcast:5 row_mask:0xf bank_mask:0xf
    v_and_b32_dpp v39, v192, v9 row_newbcast:5 row_mask:0xf bank_mask:0xf
    s_waitcnt vmcnt(6)
    s_add_u32 s34, s24, 143360
    buffer_load_dwordx4 v[108:111], v1, s[4:7], s34 offen offset:0 nt
    v_mfma_f32_16x16x32_bf16 v[10:13], v[32:35], v[80:83], v[10:13]
    v_and_b32_dpp v32, v192, v6 row_newbcast:6 row_mask:0xf bank_mask:0xf
    v_and_b32_dpp v33, v192, v7 row_newbcast:6 row_mask:0xf bank_mask:0xf
    v_and_b32_dpp v34, v192, v8 row_newbcast:6 row_mask:0xf bank_mask:0xf
    v_and_b32_dpp v35, v192, v9 row_newbcast:6 row_mask:0xf bank_mask:0xf
    s_waitcnt vmcnt(6)
    s_add_u32 s34, s24, 147456
    buffer_load_dwordx4 v[112:115], v1, s[4:7], s34 offen offset:0 nt
    v_mfma_f32_16x16x32_bf16 v[10:13], v[36:39], v[84:87], v[10:13]
    v_and_b32_dpp v36, v192, v6 row_newbcast:7 row_mask:0xf bank_mask:0xf
    v_and_b32_dpp v37, v192, v7 row_newbcast:7 row_mask:0xf bank_mask:0xf
    v_and_b32_dpp v38, v192, v8 row_newbcast:7 row_mask:0xf bank_mask:0xf
    v_and_b32_dpp v39, v192, v9 row_newbcast:7 row_mask:0xf bank_mask:0xf
    s_waitcnt vmcnt(6)
    s_add_u32 s34, s24, 151552
    buffer_load_dwordx4 v[116:119], v1, s[4:7], s34 offen offset:0 nt
    v_mfma_f32_16x16x32_bf16 v[10:13], v[32:35], v[88:91], v[10:13]
    v_and_b32_dpp v32, v192, v6 row_newbcast:8 row_mask:0xf bank_mask:0xf
    v_and_b32_dpp v33, v192, v7 row_newbcast:8 row_mask:0xf bank_mask:0xf
    v_and_b32_dpp v34, v192, v8 row_newbcast:8 row_mask:0xf bank_mask:0xf
    v_and_b32_dpp v35, v192, v9 row_newbcast:8 row_mask:0xf bank_mask:0xf
    s_waitcnt vmcnt(6)
    s_add_u32 s34, s24, 155648
    buffer_load_dwordx4 v[120:123], v1, s[4:7], s34 offen offset:0 nt
    v_mfma_f32_16x16x32_bf16 v[10:13], v[36:39], v[92:95], v[10:13]
    v_and_b32_dpp v36, v192, v6 row_newbcast:9 row_mask:0xf bank_mask:0xf
    v_and_b32_dpp v37, v192, v7 row_newbcast:9 row_mask:0xf bank_mask:0xf
    v_and_b32_dpp v38, v192, v8 row_newbcast:9 row_mask:0xf bank_mask:0xf
    v_and_b32_dpp v39, v192, v9 row_newbcast:9 row_mask:0xf bank_mask:0xf
    s_waitcnt vmcnt(6)
    s_add_u32 s34, s24, 159744
    buffer_load_dwordx4 v[124:127], v1, s[4:7], s34 offen offset:0 nt
    s_or_b32 s24, s24, 0x6ffff
    s_add_u32 s24, s24, 1
    s_bitcmp1_b32 s24, 21
    s_cselect_b32 s4, s44, s4
    s_cselect_b32 s5, s45, s5
    s_and_b32 s24, s24, 0x190000
    v_mfma_f32_16x16x32_bf16 v[10:13], v[32:35], v[96:99], v[10:13]
    v_and_b32_dpp v32, v192, v6 row_newbcast:10 row_mask:0xf bank_mask:0xf
    v_and_b32_dpp v33, v192, v7 row_newbcast:10 row_mask:0xf bank_mask:0xf
    v_and_b32_dpp v34, v192, v8 row_newbcast:10 row_mask:0xf bank_mask:0xf
    v_and_b32_dpp v35, v192, v9 row_newbcast:10 row_mask:0xf bank_mask:0xf
    s_waitcnt vmcnt(6)
    buffer_load_dwordx4 v[128:131], v1, s[8:11], s30 offen offset:0 nt
    v_mfma_f32_16x16x32_bf16 v[10:13], v[36:39], v[100:103], v[10:13]
    v_and_b32_dpp v36, v192, v6 row_newbcast:11 row_mask:0xf bank_mask:0xf
    v_and_b32_dpp v37, v192, v7 row_newbcast:11 row_mask:0xf bank_mask:0xf
    v_and_b32_dpp v38, v192, v8 row_newbcast:11 row_mask:0xf bank_mask:0xf
    v_and_b32_dpp v39, v192, v9 row_newbcast:11 row_mask:0xf bank_mask:0xf
    s_waitcnt vmcnt(6)
    s_add_u32 s34, s30, 4096
    buffer_load_dwordx4 v[132:135], v1, s[8:11], s34 offen offset:0 nt
    v_mfma_f32_16x16x32_bf16 v[10:13], v[32:35], v[104:107], v[10:13]
    v_and_b32_dpp v32, v192, v6 row_newbcast:12 row_mask:0xf bank_mask:0xf
    v_and_b32_dpp v33, v192, v7 row_newbcast:12 row_mask:0xf bank_mask:0xf
    v_and_b32_dpp v34, v192, v8 row_newbcast:12 row_mask:0xf bank_mask:0xf
    v_and_b32_dpp v35, v192, v9 row_newbcast:12 row_mask:0xf bank_mask:0xf
    s_waitcnt vmcnt(6)
    s_add_u32 s34, s30, 8192
    buffer_load_dwordx4 v[136:139], v1, s[8:11], s34 offen offset:0 nt
    buffer_load_dword v56, v55, s[20:23], s77 offen
    v_mfma_f32_16x16x32_bf16 v[10:13], v[36:39], v[108:111], v[10:13]
    v_and_b32_dpp v36, v192, v6 row_newbcast:13 row_mask:0xf bank_mask:0xf
    v_and_b32_dpp v37, v192, v7 row_newbcast:13 row_mask:0xf bank_mask:0xf
    v_and_b32_dpp v38, v192, v8 row_newbcast:13 row_mask:0xf bank_mask:0xf
    v_and_b32_dpp v39, v192, v9 row_newbcast:13 row_mask:0xf bank_mask:0xf
    s_waitcnt vmcnt(6)
    s_add_u32 s34, s30, 12288
    buffer_load_dwordx4 v[140:143], v1, s[8:11], s34 offen offset:0 nt
    v_mfma_f32_16x16x32_bf16 v[10:13], v[32:35], v[112:115], v[10:13]
    v_and_b32_dpp v32, v192, v6 row_newbcast:14 row_mask:0xf bank_mask:0xf
    v_and_b32_dpp v33, v192, v7 row_newbcast:14 row_mask:0xf bank_mask:0xf
    v_and_b32_dpp v34, v192, v8 row_newbcast:14 row_mask:0xf bank_mask:0xf
    v_and_b32_dpp v35, v192, v9 row_newbcast:14 row_mask:0xf bank_mask:0xf
    s_waitcnt vmcnt(6)
    s_add_u32 s34, s30, 16384
    buffer_load_dwordx4 v[144:147], v1, s[8:11], s34 offen offset:0 nt
    v_mfma_f32_16x16x32_bf16 v[10:13], v[36:39], v[116:119], v[10:13]
    v_and_b32_dpp v36, v192, v6 row_newbcast:15 row_mask:0xf bank_mask:0xf
    v_and_b32_dpp v37, v192, v7 row_newbcast:15 row_mask:0xf bank_mask:0xf
    v_and_b32_dpp v38, v192, v8 row_newbcast:15 row_mask:0xf bank_mask:0xf
    v_and_b32_dpp v39, v192, v9 row_newbcast:15 row_mask:0xf bank_mask:0xf
    s_waitcnt vmcnt(6)
    s_add_u32 s34, s30, 20480
    buffer_load_dwordx4 v[148:151], v1, s[8:11], s34 offen offset:0 nt
    v_mfma_f32_16x16x32_bf16 v[10:13], v[32:35], v[120:123], v[10:13]
    v_and_b32_dpp v32, v193, v6 row_newbcast:0 row_mask:0xf bank_mask:0xf
    v_and_b32_dpp v33, v193, v7 row_newbcast:0 row_mask:0xf bank_mask:0xf
    v_and_b32_dpp v34, v193, v8 row_newbcast:0 row_mask:0xf bank_mask:0xf
    v_and_b32_dpp v35, v193, v9 row_newbcast:0 row_mask:0xf bank_mask:0xf
    s_waitcnt vmcnt(6)
    s_add_u32 s34, s30, 24576
    buffer_load_dwordx4 v[152:155], v1, s[8:11], s34 offen offset:0 nt
    v_mfma_f32_16x16x32_bf16 v[10:13], v[36:39], v[124:127], v[10:13]
    v_and_b32_dpp v36, v193, v6 row_newbcast:1 row_mask:0xf bank_mask:0xf
    v_and_b32_dpp v37, v193, v7 row_newbcast:1 row_mask:0xf bank_mask:0xf
    v_and_b32_dpp v38, v193, v8 row_newbcast:1 row_mask:0xf bank_mask:0xf
    v_and_b32_dpp v39, v193, v9 row_newbcast:1 row_mask:0xf bank_mask:0xf
    s_waitcnt vmcnt(6)
    s_add_u32 s34, s30, 28672
    buffer_load_dwordx4 v[156:159], v1, s[8:11], s34 offen offset:0 nt
    v_mfma_f32_16x16x32_bf16 v[10:13], v[32:35], v[128:131], v[10:13]
    v_and_b32_dpp v32, v193, v6 row_newbcast:2 row_mask:0xf bank_mask:0xf
    v_and_b32_dpp v33, v193, v7 row_newbcast:2 row_mask:0xf bank_mask:0xf
    v_and_b32_dpp v34, v193, v8 row_newbcast:2 row_mask:0xf bank_mask:0xf
    v_and_b32_dpp v35, v193, v9 row_newbcast:2 row_mask:0xf bank_mask:0xf
    s_waitcnt vmcnt(6)
    s_add_u32 s34, s30, 131072
    buffer_load_dwordx4 v[160:163], v1, s[8:11], s34 offen offset:0 nt
    v_mfma_f32_16x16x32_bf16 v[10:13], v[36:39], v[132:135], v[10:13]
    v_and_b32_dpp v36, v193, v6 row_newbcast:3 row_mask:0xf bank_mask:0xf
    v_and_b32_dpp v37, v193, v7 row_newbcast:3 row_mask:0xf bank_mask:0xf
    v_and_b32_dpp v38, v193, v8 row_newbcast:3 row_mask:0xf bank_mask:0xf
    v_and_b32_dpp v39, v193, v9 row_newbcast:3 row_mask:0xf bank_mask:0xf
    s_waitcnt vmcnt(6)
    s_add_u32 s34, s30, 135168
    buffer_load_dwordx4 v[164:167], v1, s[8:11], s34 offen offset:0 nt
    v_mfma_f32_16x16x32_bf16 v[10:13], v[32:35], v[136:139], v[10:13]
    v_and_b32_dpp v32, v193, v6 row_newbcast:4 row_mask:0xf bank_mask:0xf
    v_and_b32_dpp v33, v193, v7 row_newbcast:4 row_mask:0xf bank_mask:0xf
    v_and_b32_dpp v34, v193, v8 row_newbcast:4 row_mask:0xf bank_mask:0xf
    v_and_b32_dpp v35, v193, v9 row_newbcast:4 row_mask:0xf bank_mask:0xf
    s_waitcnt vmcnt(6)
    s_add_u32 s34, s30, 139264
    buffer_load_dwordx4 v[168:171], v1, s[8:11], s34 offen offset:0 nt
    v_mfma_f32_16x16x32_bf16 v[10:13], v[36:39], v[140:143], v[10:13]
    v_and_b32_dpp v36, v193, v6 row_newbcast:5 row_mask:0xf bank_mask:0xf
    v_and_b32_dpp v37, v193, v7 row_newbcast:5 row_mask:0xf bank_mask:0xf
    v_and_b32_dpp v38, v193, v8 row_newbcast:5 row_mask:0xf bank_mask:0xf
    v_and_b32_dpp v39, v193, v9 row_newbcast:5 row_mask:0xf bank_mask:0xf
    s_waitcnt vmcnt(6)
    s_add_u32 s34, s30, 143360
    buffer_load_dwordx4 v[172:175], v1, s[8:11], s34 offen offset:0 nt
    v_mfma_f32_16x16x32_bf16 v[10:13], v[32:35], v[144:147], v[10:13]
    v_and_b32_dpp v32, v193, v6 row_newbcast:6 row_mask:0xf bank_mask:0xf
    v_and_b32_dpp v33, v193, v7 row_newbcast:6 row_mask:0xf bank_mask:0xf
    v_and_b32_dpp v34, v193, v8 row_newbcast:6 row_mask:0xf bank_mask:0xf
    v_and_b32_dpp v35, v193, v9 row_newbcast:6 row_mask:0xf bank_mask:0xf
    s_waitcnt vmcnt(6)
    s_add_u32 s34, s30, 147456
    buffer_load_dwordx4 v[176:179], v1, s[8:11], s34 offen offset:0 nt
    v_mfma_f32_16x16x32_bf16 v[10:13], v[36:39], v[148:151], v[10:13]
    v_and_b32_dpp v36, v193, v6 row_newbcast:7 row_mask:0xf bank_mask:0xf
    v_and_b32_dpp v37, v193, v7 row_newbcast:7 row_mask:0xf bank_mask:0xf
    v_and_b32_dpp v38, v193, v8 row_newbcast:7 row_mask:0xf bank_mask:0xf
    v_and_b32_dpp v39, v193, v9 row_newbcast:7 row_mask:0xf bank_mask:0xf
    s_waitcnt vmcnt(6)
    s_add_u32 s34, s30, 151552
    buffer_load_dwordx4 v[180:183], v1, s[8:11], s34 offen offset:0 nt
    v_mfma_f32_16x16x32_bf16 v[10:13], v[32:35], v[152:155], v[10:13]
    v_and_b32_dpp v32, v193, v6 row_newbcast:8 row_mask:0xf bank_mask:0xf
    v_and_b32_dpp v33, v193, v7 row_newbcast:8 row_mask:0xf bank_mask:0xf
    v_and_b32_dpp v34, v193, v8 row_newbcast:8 row_mask:0xf bank_mask:0xf
    v_and_b32_dpp v35, v193, v9 row_newbcast:8 row_mask:0xf bank_mask:0xf
    s_waitcnt vmcnt(6)
    s_add_u32 s34, s30, 155648
    buffer_load_dwordx4 v[184:187], v1, s[8:11], s34 offen offset:0 nt
    v_mfma_f32_16x16x32_bf16 v[10:13], v[36:39], v[156:159], v[10:13]
    v_and_b32_dpp v36, v193, v6 row_newbcast:9 row_mask:0xf bank_mask:0xf
    v_and_b32_dpp v37, v193, v7 row_newbcast:9 row_mask:0xf bank_mask:0xf
    v_and_b32_dpp v38, v193, v8 row_newbcast:9 row_mask:0xf bank_mask:0xf
    v_and_b32_dpp v39, v193, v9 row_newbcast:9 row_mask:0xf bank_mask:0xf
    s_waitcnt vmcnt(6)
    s_add_u32 s34, s30, 159744
    buffer_load_dwordx4 v[188:191], v1, s[8:11], s34 offen offset:0 nt
    s_or_b32 s30, s30, 0x6ffff
    s_add_u32 s30, s30, 1
    s_bitcmp1_b32 s30, 21
    s_cselect_b32 s8, s44, s8
    s_cselect_b32 s9, s45, s9
    s_and_b32 s30, s30, 0x190000
    s_or_b32 s30, s30, 0x40000
    v_mfma_f32_16x16x32_bf16 v[10:13], v[32:35], v[160:163], v[10:13]
    v_and_b32_dpp v32, v193, v6 row_newbcast:10 row_mask:0xf bank_mask:0xf
    v_and_b32_dpp v33, v193, v7 row_newbcast:10 row_mask:0xf bank_mask:0xf
    v_and_b32_dpp v34, v193, v8 row_newbcast:10 row_mask:0xf bank_mask:0xf
    v_and_b32_dpp v35, v193, v9 row_newbcast:10 row_mask:0xf bank_mask:0xf
    s_waitcnt vmcnt(6)
    buffer_load_dwordx4 v[64:67], v1, s[4:7], s24 offen offset:0 nt
    v_mfma_f32_16x16x32_bf16 v[10:13], v[36:39], v[164:167], v[10:13]
    v_and_b32_dpp v36, v193, v6 row_newbcast:11 row_mask:0xf bank_mask:0xf
    v_and_b32_dpp v37, v193, v7 row_newbcast:11 row_mask:0xf bank_mask:0xf
    v_and_b32_dpp v38, v193, v8 row_newbcast:11 row_mask:0xf bank_mask:0xf
    v_and_b32_dpp v39, v193, v9 row_newbcast:11 row_mask:0xf bank_mask:0xf
    s_waitcnt vmcnt(6)
    s_add_u32 s34, s24, 4096
    buffer_load_dwordx4 v[68:71], v1, s[4:7], s34 offen offset:0 nt
    v_mfma_f32_16x16x32_bf16 v[10:13], v[32:35], v[168:171], v[10:13]
    v_and_b32_dpp v32, v193, v6 row_newbcast:12 row_mask:0xf bank_mask:0xf
    v_and_b32_dpp v33, v193, v7 row_newbcast:12 row_mask:0xf bank_mask:0xf
    v_and_b32_dpp v34, v193, v8 row_newbcast:12 row_mask:0xf bank_mask:0xf
    v_and_b32_dpp v35, v193, v9 row_newbcast:12 row_mask:0xf bank_mask:0xf
    s_waitcnt vmcnt(6)
    s_add_u32 s34, s24, 8192
    buffer_load_dwordx4 v[72:75], v1, s[4:7], s34 offen offset:0 nt
    v_mfma_f32_16x16x32_bf16 v[10:13], v[36:39], v[172:175], v[10:13]
    v_and_b32_dpp v36, v193, v6 row_newbcast:13 row_mask:0xf bank_mask:0xf
    v_and_b32_dpp v37, v193, v7 row_newbcast:13 row_mask:0xf bank_mask:0xf
    v_and_b32_dpp v38, v193, v8 row_newbcast:13 row_mask:0xf bank_mask:0xf
    v_and_b32_dpp v39, v193, v9 row_newbcast:13 row_mask:0xf bank_mask:0xf
    s_waitcnt vmcnt(6)
    s_add_u32 s34, s24, 12288
    buffer_load_dwordx4 v[76:79], v1, s[4:7], s34 offen offset:0 nt
    v_mfma_f32_16x16x32_bf16 v[10:13], v[32:35], v[176:179], v[10:13]
    v_and_b32_dpp v32, v193, v6 row_newbcast:14 row_mask:0xf bank_mask:0xf
    v_and_b32_dpp v33, v193, v7 row_newbcast:14 row_mask:0xf bank_mask:0xf
    v_and_b32_dpp v34, v193, v8 row_newbcast:14 row_mask:0xf bank_mask:0xf
    v_and_b32_dpp v35, v193, v9 row_newbcast:14 row_mask:0xf bank_mask:0xf
    s_waitcnt vmcnt(6)
    s_add_u32 s34, s24, 16384
    buffer_load_dwordx4 v[80:83], v1, s[4:7], s34 offen offset:0 nt
    v_sub_u32 v57, v56, v58
    v_mov_b32 v58, v56
    v_add_u32 v56, v56, v57
    v_subrev_u32 v56, s68, v56
    v_and_b32 v57, 0x3ff, v56
    v_cmp_eq_u32 s[70:71], 0, v57
    v_cmp_gt_i32 vcc, 0xffff6000, v56
    s_and_b32 s72, vcc_lo, s70
    v_cmp_lt_i32 vcc, 0xf000, v56
    s_bcnt1_i32_b32 s72, s72
    s_orn2_b32 s73, vcc_lo, s70
    s_bcnt1_i32_b32 s73, s73
    s_cmp_gt_u32 s73, 16
    s_cselect_b32 s78, 1, 0
    s_cmp_ge_u32 s72, 16
    s_cselect_b32 s78, 2, s78
    s_cmp_ge_u32 s33, 12
    s_cselect_b32 s78, 0, s78
    v_mfma_f32_16x16x32_bf16 v[10:13], v[36:39], v[180:183], v[10:13]
    v_and_b32_dpp v36, v193, v6 row_newbcast:15 row_mask:0xf bank_mask:0xf
    v_and_b32_dpp v37, v193, v7 row_newbcast:15 row_mask:0xf bank_mask:0xf
    v_and_b32_dpp v38, v193, v8 row_newbcast:15 row_mask:0xf bank_mask:0xf
    v_and_b32_dpp v39, v193, v9 row_newbcast:15 row_mask:0xf bank_mask:0xf
    s_waitcnt vmcnt(6)
    s_add_u32 s34, s24, 20480
    buffer_load_dwordx4 v[84:87], v1, s[4:7], s34 offen offset:0 nt
    v_mfma_f32_16x16x32_bf16 v[10:13], v[32:35], v[184:187], v[10:13]
    s_waitcnt vmcnt(6)
    s_add_u32 s34, s24, 24576
    buffer_load_dwordx4 v[88:91], v1, s[4:7], s34 offen offset:0 nt
    s_nop 0
    v_mfma_f32_16x16x32_bf16 v[10:13], v[36:39], v[188:191], v[10:13]
    v_mov_b32 v192, v194
    v_mov_b32 v193, v195
    v_mov_b32 v194, v196
    v_mov_b32 v195, v197
    v_mov_b32 v196, v198
    v_mov_b32 v197, v199
    v_mov_b32 v198, v200
    v_mov_b32 v199, v201
    v_mov_b32 v200, v202
    v_mov_b32 v201, v203
    v_mov_b32 v202, v204
    v_mov_b32 v203, v205
    v_mov_b32 v204, v206
    v_mov_b32 v205, v207
    s_sub_u32 s33, s33, 1
    s_cmp_lg_u32 s33, 0
    s_cbranch_scc1 L_loop2
L_last:
    s_cmp_eq_u32 s78, 1
    s_cbranch_scc1 L_w1
    s_cmp_eq_u32 s78, 2
    s_cbranch_scc1 L_w2
L_w0:
    v_and_b32_dpp v32, v192, v6 row_newbcast:0 row_mask:0xf bank_mask:0xf
    v_and_b32_dpp v33, v192, v7 row_newbcast:0 row_mask:0xf bank_mask:0xf
    v_and_b32_dpp v34, v192, v8 row_newbcast:0 row_mask:0xf bank_mask:0xf
    v_and_b32_dpp v35, v192, v9 row_newbcast:0 row_mask:0xf bank_mask:0xf
    v_and_b32_dpp v36, v192, v6 row_newbcast:1 row_mask:0xf bank_mask:0xf
    v_and_b32_dpp v37, v192, v7 row_newbcast:1 row_mask:0xf bank_mask:0xf
    v_and_b32_dpp v38, v192, v8 row_newbcast:1 row_mask:0xf bank_mask:0xf
    v_and_b32_dpp v39, v192, v9 row_newbcast:1 row_mask:0xf bank_mask:0xf
    s_waitcnt vmcnt(5)
    s_add_u32 s34, s24, 28672
    buffer_load_dwordx4 v[92:95], v1, s[4:7], s34 offen offset:0 nt
    v_mfma_f32_16x16x32_bf16 v[10:13], v[32:35], v[64:67], v[10:13]
    v_and_b32_dpp v32, v192, v6 row_newbcast:2 row_mask:0xf bank_mask:0xf
    v_and_b32_dpp v33, v192, v7 row_newbcast:2 row_mask:0xf bank_mask:0xf
    v_and_b32_dpp v34, v192, v8 row_newbcast:2 row_mask:0xf bank_mask:0xf
    v_and_b32_dpp v35, v192, v9 row_newbcast:2 row_mask:0xf bank_mask:0xf
    s_waitcnt vmcnt(5)
    s_add_u32 s34, s24, 131072
    buffer_load_dwordx4 v[96:99], v1, s[4:7], s34 offen offset:0 nt
    v_mfma_f32_16x16x32_bf16 v[10:13], v[36:39], v[68:71], v[10:13]
    v_and_b32_dpp v36, v192, v6 row_newbcast:3 row_mask:0xf bank_mask:0xf
    v_and_b32_dpp v37, v192, v7 row_newbcast:3 row_mask:0xf bank_mask:0xf
    v_and_b32_dpp v38, v192, v8 row_newbcast:3 row_mask:0xf bank_mask:0xf
    v_and_b32_dpp v39, v192, v9 row_newbcast:3 row_mask:0xf bank_mask:0xf
    s_waitcnt vmcnt(5)
    s_add_u32 s34, s24, 135168
    buffer_load_dwordx4 v[100:103], v1, s[4:7], s34 offen offset:0 nt
    v_mfma_f32_16x16x32_bf16 v[10:13], v[32:35], v[72:75], v[10:13]
    v_and_b32_dpp v32, v192, v6 row_newbcast:4 row_mask:0xf bank_mask:0xf
    v_and_b32_dpp v33, v192, v7 row_newbcast:4 row_mask:0xf bank_mask:0xf
    v_and_b32_dpp v34, v192, v8 row_newbcast:4 row_mask:0xf bank_mask:0xf
    v_and_b32_dpp v35, v192, v9 row_newbcast:4 row_mask:0xf bank_mask:0xf
    s_waitcnt vmcnt(5)
    s_add_u32 s34, s24, 139264
    buffer_load_dwordx4 v[104:107], v1, s[4:7], s34 offen offset:0 nt
    v_mfma_f32_16x16x32_bf16 v[10:13], v[36:39], v[76:79], v[10:13]
    v_and_b32_dpp v36, v192, v6 row_newbcast:5 row_mask:0xf bank_mask:0xf
    v_and_b32_dpp v37, v192, v7 row_newbcast:5 row_mask:0xf bank_mask:0xf
    v_and_b32_dpp v38, v192, v8 row_newbcast:5 row_mask:0xf bank_mask:0xf
    v_and_b32_dpp v39, v192, v9 row_newbcast:5 row_mask:0xf bank_mask:0xf
    s_waitcnt vmcnt(5)
    s_add_u32 s34, s24, 143360
    buffer_load_dwordx4 v[108:111], v1, s[4:7], s34 offen offset:0 nt
    v_mfma_f32_16x16x32_bf16 v[10:13], v[32:35], v[80:83], v[10:13]
    v_and_b32_dpp v32, v192, v6 row_newbcast:6 row_mask:0xf bank_mask:0xf
    v_and_b32_dpp v33, v192, v7 row_newbcast:6 row_mask:0xf bank_mask:0xf
    v_and_b32_dpp v34, v192, v8 row_newbcast:6 row_mask:0xf bank_mask:0xf
    v_and_b32_dpp v35, v192, v9 row_newbcast:6 row_mask:0xf bank_mask:0xf
    s_waitcnt vmcnt(5)
    s_add_u32 s34, s24, 147456
    buffer_load_dwordx4 v[112:115], v1, s[4:7], s34 offen offset:0 nt
    v_mfma_f32_16x16x32_bf16 v[10:13], v[36:39], v[84:87], v[10:13]
    v_and_b32_dpp v36, v192, v6 row_newbcast:7 row_mask:0xf bank_mask:0xf
    v_and_b32_dpp v37, v192, v7 row_newbcast:7 row_mask:0xf bank_mask:0xf
    v_and_b32_dpp v38, v192, v8 row_newbcast:7 row_mask:0xf bank_mask:0xf
    v_and_b32_dpp v39, v192, v9 row_newbcast:7 row_mask:0xf bank_mask:0xf
    s_waitcnt vmcnt(5)
    s_add_u32 s34, s24, 151552
    buffer_load_dwordx4 v[116:119], v1, s[4:7], s34 offen offset:0 nt
    v_mfma_f32_16x16x32_bf16 v[10:13], v[32:35], v[88:91], v[10:13]
    v_and_b32_dpp v32, v192, v6 row_newbcast:8 row_mask:0xf bank_mask:0xf
    v_and_b32_dpp v33, v192, v7 row_newbcast:8 row_mask:0xf bank_mask:0xf
    v_and_b32_dpp v34, v192, v8 row_newbcast:8 row_mask:0xf bank_mask:0xf
    v_and_b32_dpp v35, v192, v9 row_newbcast:8 row_mask:0xf bank_mask:0xf
    s_waitcnt vmcnt(5)
    s_add_u32 s34, s24, 155648
    buffer_load_dwordx4 v[120:123], v1, s[4:7], s34 offen offset:0 nt
    v_mfma_f32_16x16x32_bf16 v[10:13], v[36:39], v[92:95], v[10:13]
    v_and_b32_dpp v36, v192, v6 row_newbcast:9 row_mask:0xf bank_mask:0xf
    v_and_b32_dpp v37, v192, v7 row_newbcast:9 row_mask:0xf bank_mask:0xf
    v_and_b32_dpp v38, v192, v8 row_newbcast:9 row_mask:0xf bank_mask:0xf
    v_and_b32_dpp v39, v192, v9 row_newbcast:9 row_mask:0xf bank_mask:0xf
    s_waitcnt vmcnt(5)
    s_add_u32 s34, s24, 159744
    buffer_load_dwordx4 v[124:127], v1, s[4:7], s34 offen offset:0 nt
    s_or_b32 s24, s24, 0x6ffff
    s_add_u32 s24, s24, 1
    s_bitcmp1_b32 s24, 21
    s_cselect_b32 s4, s44, s4
    s_cselect_b32 s5, s45, s5
    s_and_b32 s24, s24, 0x190000
    v_mfma_f32_16x16x32_bf16 v[10:13], v[32:35], v[96:99], v[10:13]
    v_and_b32_dpp v32, v192, v6 row_newbcast:10 row_mask:0xf bank_mask:0xf
    v_and_b32_dpp v33, v192, v7 row_newbcast:10 row_mask:0xf bank_mask:0xf
    v_and_b32_dpp v34, v192, v8 row_newbcast:10 row_mask:0xf bank_mask:0xf
    v_and_b32_dpp v35, v192, v9 row_newbcast:10 row_mask:0xf bank_mask:0xf
    s_waitcnt vmcnt(5)
    buffer_load_dwordx4 v[128:131], v1, s[8:11], s30 offen offset:0 nt
    v_mfma_f32_16x16x32_bf16 v[10:13], v[36:39], v[100:103], v[10:13]
    v_and_b32_dpp v36, v192, v6 row_newbcast:11 row_mask:0xf bank_mask:0xf
    v_and_b32_dpp v37, v192, v7 row_newbcast:11 row_mask:0xf bank_mask:0xf
    v_and_b32_dpp v38, v192, v8 row_newbcast:11 row_mask:0xf bank_mask:0xf
    v_and_b32_dpp v39, v192, v9 row_newbcast:11 row_mask:0xf bank_mask:0xf
    s_waitcnt vmcnt(5)
    s_add_u32 s34, s30, 4096
    buffer_load_dwordx4 v[132:135], v1, s[8:11], s34 offen offset:0 nt
    v_mfma_f32_16x16x32_bf16 v[10:13], v[32:35], v[104:107], v[10:13]
    v_and_b32_dpp v32, v192, v6 row_newbcast:12 row_mask:0xf bank_mask:0xf
    v_and_b32_dpp v33, v192, v7 row_newbcast:12 row_mask:0xf bank_mask:0xf
    v_and_b32_dpp v34, v192, v8 row_newbcast:12 row_mask:0xf bank_mask:0xf
    v_and_b32_dpp v35, v192, v9 row_newbcast:12 row_mask:0xf bank_mask:0xf
    s_waitcnt vmcnt(5)
    s_add_u32 s34, s30, 8192
    buffer_load_dwordx4 v[136:139], v1, s[8:11], s34 offen offset:0 nt
    v_mfma_f32_16x16x32_bf16 v[10:13], v[36:39], v[108:111], v[10:13]
    v_and_b32_dpp v36, v192, v6 row_newbcast:13 row_mask:0xf bank_mask:0xf
    v_and_b32_dpp v37, v192, v7 row_newbcast:13 row_mask:0xf bank_mask:0xf
    v_and_b32_dpp v38, v192, v8 row_newbcast:13 row_mask:0xf bank_mask:0xf
    v_and_b32_dpp v39, v192, v9 row_newbcast:13 row_mask:0xf bank_mask:0xf
    s_waitcnt vmcnt(5)
    s_add_u32 s34, s30, 12288
    buffer_load_dwordx4 v[140:143], v1, s[8:11], s34 offen offset:0 nt
    v_mfma_f32_16x16x32_bf16 v[10:13], v[32:35], v[112:115], v[10:13]
    v_and_b32_dpp v32, v192, v6 row_newbcast:14 row_mask:0xf bank_mask:0xf
    v_and_b32_dpp v33, v192, v7 row_newbcast:14 row_mask:0xf bank_mask:0xf
    v_and_b32_dpp v34, v192, v8 row_newbcast:14 row_mask:0xf bank_mask:0xf
    v_and_b32_dpp v35, v192, v9 row_newbcast:14 row_mask:0xf bank_mask:0xf
    s_waitcnt vmcnt(5)
    s_add_u32 s34, s30, 16384
    buffer_load_dwordx4 v[144:147], v1, s[8:11], s34 offen offset:0 nt
    v_mfma_f32_16x16x32_bf16 v[10:13], v[36:39], v[116:119], v[10:13]
    v_and_b32_dpp v36, v192, v6 row_newbcast:15 row_mask:0xf bank_mask:0xf
    v_and_b32_dpp v37, v192, v7 row_newbcast:15 row_mask:0xf bank_mask:0xf
    v_and_b32_dpp v38, v192, v8 row_newbcast:15 row_mask:0xf bank_mask:0xf
    v_and_b32_dpp v39, v192, v9 row_newbcast:15 row_mask:0xf bank_mask:0xf
    s_waitcnt vmcnt(5)
    s_add_u32 s34, s30, 20480
    buffer_load_dwordx4 v[148:151], v1, s[8:11], s34 offen offset:0 nt
    v_mfma_f32_16x16x32_bf16 v[10:13], v[32:35], v[120:123], v[10:13]
    v_and_b32_dpp v32, v193, v6 row_newbcast:0 row_mask:0xf bank_mask:0xf
    v_and_b32_dpp v33, v193, v7 row_newbcast:0 row_mask:0xf bank_mask:0xf
    v_and_b32_dpp v34, v193, v8 row_newbcast:0 row_mask:0xf bank_mask:0xf
    v_and_b32_dpp v35, v193, v9 row_newbcast:0 row_mask:0xf bank_mask:0xf
    s_waitcnt vmcnt(5)
    s_add_u32 s34, s30, 24576
    buffer_load_dwordx4 v[152:155], v1, s[8:11], s34 offen offset:0 nt
    v_mfma_f32_16x16x32_bf16 v[10:13], v[36:39], v[124:127], v[10:13]
    v_and_b32_dpp v36, v193, v6 row_newbcast:1 row_mask:0xf bank_mask:0xf
    v_and_b32_dpp v37, v193, v7 row_newbcast:1 row_mask:0xf bank_mask:0xf
    v_and_b32_dpp v38, v193, v8 row_newbcast:1 row_mask:0xf bank_mask:0xf
    v_and_b32_dpp v39, v193, v9 row_newbcast:1 row_mask:0xf bank_mask:0xf
    s_waitcnt vmcnt(5)
    s_add_u32 s34, s30, 28672
    buffer_load_dwordx4 v[156:159], v1, s[8:11], s34 offen offset:0 nt
    v_mfma_f32_16x16x32_bf16 v[10:13], v[32:35], v[128:131], v[10:13]
    v_and_b32_dpp v32, v193, v6 row_newbcast:2 row_mask:0xf bank_mask:0xf
    v_and_b32_dpp v33, v193, v7 row_newbcast:2 row_mask:0xf bank_mask:0xf
    v_and_b32_dpp v34, v193, v8 row_newbcast:2 row_mask:0xf bank_mask:0xf
    v_and_b32_dpp v35, v193, v9 row_newbcast:2 row_mask:0xf bank_mask:0xf
    s_waitcnt vmcnt(5)
    s_add_u32 s34, s30, 131072
    buffer_load_dwordx4 v[160:163], v1, s[8:11], s34 offen offset:0 nt
    v_mfma_f32_16x16x32_bf16 v[10:13], v[36:39], v[132:135], v[10:13]
    v_and_b32_dpp v36, v193, v6 row_newbcast:3 row_mask:0xf bank_mask:0xf
    v_and_b32_dpp v37, v193, v7 row_newbcast:3 row_mask:0xf bank_mask:0xf
    v_and_b32_dpp v38, v193, v8 row_newbcast:3 row_mask:0xf bank_mask:0xf
    v_and_b32_dpp v39, v193, v9 row_newbcast:3 row_mask:0xf bank_mask:0xf
    s_waitcnt vmcnt(5)
    s_add_u32 s34, s30, 135168
    buffer_load_dwordx4 v[164:167], v1, s[8:11], s34 offen offset:0 nt
    v_mfma_f32_16x16x32_bf16 v[10:13], v[32:35], v[136:139], v[10:13]
    v_and_b32_dpp v32, v193, v6 row_newbcast:4 row_mask:0xf bank_mask:0xf
    v_and_b32_dpp v33, v193, v7 row_newbcast:4 row_mask:0xf bank_mask:0xf
    v_and_b32_dpp v34, v193, v8 row_newbcast:4 row_mask:0xf bank_mask:0xf
    v_and_b32_dpp v35, v193, v9 row_newbcast:4 row_mask:0xf bank_mask:0xf
    s_waitcnt vmcnt(5)
    s_add_u32 s34, s30, 139264
    buffer_load_dwordx4 v[168:171], v1, s[8:11], s34 offen offset:0 nt
    v_mfma_f32_16x16x32_bf16 v[10:13], v[36:39], v[140:143], v[10:13]
    v_and_b32_dpp v36, v193, v6 row_newbcast:5 row_mask:0xf bank_mask:0xf
    v_and_b32_dpp v37, v193, v7 row_newbcast:5 row_mask:0xf bank_mask:0xf
    v_and_b32_dpp v38, v193, v8 row_newbcast:5 row_mask:0xf bank_mask:0xf
    v_and_b32_dpp v39, v193, v9 row_newbcast:5 row_mask:0xf bank_mask:0xf
    s_waitcnt vmcnt(5)
    s_add_u32 s34, s30, 143360
    buffer_load_dwordx4 v[172:175], v1, s[8:11], s34 offen offset:0 nt
    v_mfma_f32_16x16x32_bf16 v[10:13], v[32:35], v[144:147], v[10:13]
    v_and_b32_dpp v32, v193, v6 row_newbcast:6 row_mask:0xf bank_mask:0xf
    v_and_b32_dpp v33, v193, v7 row_newbcast:6 row_mask:0xf bank_mask:0xf
    v_and_b32_dpp v34, v193, v8 row_newbcast:6 row_mask:0xf bank_mask:0xf
    v_and_b32_dpp v35, v193, v9 row_newbcast:6 row_mask:0xf bank_mask:0xf
    s_waitcnt vmcnt(5)
    s_add_u32 s34, s30, 147456
    buffer_load_dwordx4 v[176:179], v1, s[8:11], s34 offen offset:0 nt
    v_mfma_f32_16x16x32_bf16 v[10:13], v[36:39], v[148:151], v[10:13]
    v_and_b32_dpp v36, v193, v6 row_newbcast:7 row_mask:0xf bank_mask:0xf
    v_and_b32_dpp v37, v193, v7 row_newbcast:7 row_mask:0xf bank_mask:0xf
    v_and_b32_dpp v38, v193, v8 row_newbcast:7 row_mask:0xf bank_mask:0xf
    v_and_b32_dpp v39, v193, v9 row_newbcast:7 row_mask:0xf bank_mask:0xf
    s_waitcnt vmcnt(5)
    s_add_u32 s34, s30, 151552
    buffer_load_dwordx4 v[180:183], v1, s[8:11], s34 offen offset:0 nt
    v_mfma_f32_16x16x32_bf16 v[10:13], v[32:35], v[152:155], v[10:13]
    v_and_b32_dpp v32, v193, v6 row_newbcast:8 row_mask:0xf bank_mask:0xf
    v_and_b32_dpp v33, v193, v7 row_newbcast:8 row_mask:0xf bank_mask:0xf
    v_and_b32_dpp v34, v193, v8 row_newbcast:8 row_mask:0xf bank_mask:0xf
    v_and_b32_dpp v35, v193, v9 row_newbcast:8 row_mask:0xf bank_mask:0xf
    s_waitcnt vmcnt(5)
    s_add_u32 s34, s30, 155648
    buffer_load_dwordx4 v[184:187], v1, s[8:11], s34 offen offset:0 nt
    v_mfma_f32_16x16x32_bf16 v[10:13], v[36:39], v[156:159], v[10:13]
    v_and_b32_dpp v36, v193, v6 row_newbcast:9 row_mask:0xf bank_mask:0xf
    v_and_b32_dpp v37, v193, v7 row_newbcast:9 row_mask:0xf bank_mask:0xf
    v_and_b32_dpp v38, v193, v8 row_newbcast:9 row_mask:0xf bank_mask:0xf
    v_and_b32_dpp v39, v193, v9 row_newbcast:9 row_mask:0xf bank_mask:0xf
    s_waitcnt vmcnt(5)
    s_add_u32 s34, s30, 159744
    buffer_load_dwordx4 v[188:191], v1, s[8:11], s34 offen offset:0 nt
    s_or_b32 s30, s30, 0x6ffff
    s_add_u32 s30, s30, 1
    s_bitcmp1_b32 s30, 21
    s_cselect_b32 s8, s44, s8
    s_cselect_b32 s9, s45, s9
    s_and_b32 s30, s30, 0x190000
    s_or_b32 s30, s30, 0x40000
    v_mfma_f32_16x16x32_bf16 v[10:13], v[32:35], v[160:163], v[10:13]
    v_and_b32_dpp v32, v193, v6 row_newbcast:10 row_mask:0xf bank_mask:0xf
    v_and_b32_dpp v33, v193, v7 row_newbcast:10 row_mask:0xf bank_mask:0xf
    v_and_b32_dpp v34, v193, v8 row_newbcast:10 row_mask:0xf bank_mask:0xf
    v_and_b32_dpp v35, v193, v9 row_newbcast:10 row_mask:0xf bank_mask:0xf
    s_waitcnt vmcnt(6)
    v_mfma_f32_16x16x32_bf16 v[10:13], v[36:39], v[164:167], v[10:13]
    v_and_b32_dpp v36, v193, v6 row_newbcast:11 row_mask:0xf bank_mask:0xf
    v_and_b32_dpp v37, v193, v7 row_newbcast:11 row_mask:0xf bank_mask:0xf
    v_and_b32_dpp v38, v193, v8 row_newbcast:11 row_mask:0xf bank_mask:0xf
    v_and_b32_dpp v39, v193, v9 row_newbcast:11 row_mask:0xf bank_mask:0xf
    s_waitcnt vmcnt(5)
    v_mfma_f32_16x16x32_bf16 v[10:13], v[32:35], v[168:171], v[10:13]
    v_and_b32_dpp v32, v193, v6 row_newbcast:12 row_mask:0xf bank_mask:0xf
    v_and_b32_dpp v33, v193, v7 row_newbcast:12 row_mask:0xf bank_mask:0xf
    v_and_b32_dpp v34, v193, v8 row_newbcast:12 row_mask:0xf bank_mask:0xf
    v_and_b32_dpp v35, v193, v9 row_newbcast:12 row_mask:0xf bank_mask:0xf
    s_waitcnt vmcnt(4)
    v_mfma_f32_16x16x32_bf16 v[10:13], v[36:39], v[172:175], v[10:13]
    v_and_b32_dpp v36, v193, v6 row_newbcast:13 row_mask:0xf bank_mask:0xf
    v_and_b32_dpp v37, v193, v7 row_newbcast:13 row_mask:0xf bank_mask:0xf
    v_and_b32_dpp v38, v193, v8 row_newbcast:13 row_mask:0xf bank_mask:0xf
    v_and_b32_dpp v39, v193, v9 row_newbcast:13 row_mask:0xf bank_mask:0xf
    s_waitcnt vmcnt(3)
    v_mfma_f32_16x16x32_bf16 v[10:13], v[32:35], v[176:179], v[10:13]
    v_and_b32_dpp v32, v193, v6 row_newbcast:14 row_mask:0xf bank_mask:0xf
    v_and_b32_dpp v33, v193, v7 row_newbcast:14 row_mask:0xf bank_mask:0xf
    v_and_b32_dpp v34, v193, v8 row_newbcast:14 row_mask:0xf bank_mask:0xf
    v_and_b32_dpp v35, v193, v9 row_newbcast:14 row_mask:0xf bank_mask:0xf
    s_waitcnt vmcnt(2)
    v_mfma_f32_16x16x32_bf16 v[10:13], v[36:39], v[180:183], v[10:13]
    v_and_b32_dpp v36, v193, v6 row_newbcast:15 row_mask:0xf bank_mask:0xf
    v_and_b32_dpp v37, v193, v7 row_newbcast:15 row_mask:0xf bank_mask:0xf
    v_and_b32_dpp v38, v193, v8 row_newbcast:15 row_mask:0xf bank_mask:0xf
    v_and_b32_dpp v39, v193, v9 row_newbcast:15 row_mask:0xf bank_mask:0xf
    s_waitcnt vmcnt(1)
    v_mfma_f32_16x16x32_bf16 v[10:13], v[32:35], v[184:187], v[10:13]
    s_waitcnt vmcnt(0)
    s_nop 0
    v_mfma_f32_16x16x32_bf16 v[10:13], v[36:39], v[188:191], v[10:13]
    s_branch L_send
L_w1:
    v_and_b32_dpp v32, v192, v6 row_newbcast:0 row_mask:0xf bank_mask:0xf
    v_and_b32_dpp v33, v192, v7 row_newbcast:0 row_mask:0xf bank_mask:0xf
    v_and_b32_dpp v34, v192, v8 row_newbcast:0 row_mask:0xf bank_mask:0xf
    v_and_b32_dpp v35, v192, v9 row_newbcast:0 row_mask:0xf bank_mask:0xf
    v_and_b32_dpp v36, v192, v6 row_newbcast:1 row_mask:0xf bank_mask:0xf
    v_and_b32_dpp v37, v192, v7 row_newbcast:1 row_mask:0xf bank_mask:0xf
    v_and_b32_dpp v38, v192, v8 row_newbcast:1 row_mask:0xf bank_mask:0xf
    v_and_b32_dpp v39, v192, v9 row_newbcast:1 row_mask:0xf bank_mask:0xf
    s_waitcnt vmcnt(4)
    s_add_u32 s34, s24, 28672
    buffer_load_dwordx4 v[92:95], v1, s[4:7], s34 offen offset:0 nt
    v_mfma_f32_16x16x32_bf16 v[10:13], v[32:35], v[64:67], v[10:13]
    v_and_b32_dpp v32, v192, v6 row_newbcast:2 row_mask:0xf bank_mask:0xf
    v_and_b32_dpp v33, v192, v7 row_newbcast:2 row_mask:0xf bank_mask:0xf
    v_and_b32_dpp v34, v192, v8 row_newbcast:2 row_mask:0xf bank_mask:0xf
    v_and_b32_dpp v35, v192, v9 row_newbcast:2 row_mask:0xf bank_mask:0xf
    s_waitcnt vmcnt(4)
    s_add_u32 s34, s24, 131072
    buffer_load_dwordx4 v[96:99], v1, s[4:7], s34 offen offset:0 nt
    v_mfma_f32_16x16x32_bf16 v[10:13], v[36:39], v[68:71], v[10:13]
    v_and_b32_dpp v36, v192, v6 row_newbcast:3 row_mask:0xf bank_mask:0xf
    v_and_b32_dpp v37, v192, v7 row_newbcast:3 row_mask:0xf bank_mask:0xf
    v_and_b32_dpp v38, v192, v8 row_newbcast:3 row_mask:0xf bank_mask:0xf
    v_and_b32_dpp v39, v192, v9 row_newbcast:3 row_mask:0xf bank_mask:0xf
    s_waitcnt vmcnt(4)
    s_add_u32 s34, s24, 135168
    buffer_load_dwordx4 v[100:103], v1, s[4:7], s34 offen offset:0 nt
    v_mfma_f32_16x16x32_bf16 v[10:13], v[32:35], v[72:75], v[10:13]
    v_and_b32_dpp v32, v192, v6 row_newbcast:4 row_mask:0xf bank_mask:0xf
    v_and_b32_dpp v33, v192, v7 row_newbcast:4 row_mask:0xf bank_mask:0xf
    v_and_b32_dpp v34, v192, v8 row_newbcast:4 row_mask:0xf bank_mask:0xf
    v_and_b32_dpp v35, v192, v9 row_newbcast:4 row_mask:0xf bank_mask:0xf
    s_waitcnt vmcnt(4)
    s_add_u32 s34, s24, 139264
    buffer_load_dwordx4 v[104:107], v1, s[4:7], s34 offen offset:0 nt
    v_mfma_f32_16x16x32_bf16 v[10:13], v[36:39], v[76:79], v[10:13]
    v_and_b32_dpp v36, v192, v6 row_newbcast:5 row_mask:0xf bank_mask:0xf
    v_and_b32_dpp v37, v192, v7 row_newbcast:5 row_mask:0xf bank_mask:0xf
    v_and_b32_dpp v38, v192, v8 row_newbcast:5 row_mask:0xf bank_mask:0xf
    v_and_b32_dpp v39, v192, v9 row_newbcast:5 row_mask:0xf bank_mask:0xf
    s_waitcnt vmcnt(4)
    s_add_u32 s34, s24, 143360
    buffer_load_dwordx4 v[108:111], v1, s[4:7], s34 offen offset:0 nt
    v_mfma_f32_16x16x32_bf16 v[10:13], v[32:35], v[80:83], v[10:13]
    v_and_b32_dpp v32, v192, v6 row_newbcast:6 row_mask:0xf bank_mask:0xf
    v_and_b32_dpp v33, v192, v7 row_newbcast:6 row_mask:0xf bank_mask:0xf
    v_and_b32_dpp v34, v192, v8 row_newbcast:6 row_mask:0xf bank_mask:0xf
    v_and_b32_dpp v35, v192, v9 row_newbcast:6 row_mask:0xf bank_mask:0xf
    s_waitcnt vmcnt(4)
    s_add_u32 s34, s24, 147456
    buffer_load_dwordx4 v[112:115], v1, s[4:7], s34 offen offset:0 nt
    v_mfma_f32_16x16x32_bf16 v[10:13], v[36:39], v[84:87], v[10:13]
    v_and_b32_dpp v36, v192, v6 row_newbcast:7 row_mask:0xf bank_mask:0xf
    v_and_b32_dpp v37, v192, v7 row_newbcast:7 row_mask:0xf bank_mask:0xf
    v_and_b32_dpp v38, v192, v8 row_newbcast:7 row_mask:0xf bank_mask:0xf
    v_and_b32_dpp v39, v192, v9 row_newbcast:7 row_mask:0xf bank_mask:0xf
    s_waitcnt vmcnt(4)
    s_add_u32 s34, s24, 151552
    buffer_load_dwordx4 v[116:119], v1, s[4:7], s34 offen offset:0 nt
    v_mfma_f32_16x16x32_bf16 v[10:13], v[32:35], v[88:91], v[10:13]
    v_and_b32_dpp v32, v192, v6 row_newbcast:8 row_mask:0xf bank_mask:0xf
    v_and_b32_dpp v33, v192, v7 row_newbcast:8 row_mask:0xf bank_mask:0xf
    v_and_b32_dpp v34, v192, v8 row_newbcast:8 row_mask:0xf bank_mask:0xf
    v_and_b32_dpp v35, v192, v9 row_newbcast:8 row_mask:0xf bank_mask:0xf
    s_waitcnt vmcnt(4)
    s_add_u32 s34, s24, 155648
    buffer_load_dwordx4 v[120:123], v1, s[4:7], s34 offen offset:0 nt
    v_mfma_f32_16x16x32_bf16 v[10:13], v[36:39], v[92:95], v[10:13]
    v_and_b32_dpp v36, v192, v6 row_newbcast:9 row_mask:0xf bank_mask:0xf
    v_and_b32_dpp v37, v192, v7 row_newbcast:9 row_mask:0xf bank_mask:0xf
    v_and_b32_dpp v38, v192, v8 row_newbcast:9 row_mask:0xf bank_mask:0xf
    v_and_b32_dpp v39, v192, v9 row_newbcast:9 row_mask:0xf bank_mask:0xf
    s_waitcnt vmcnt(4)
    s_add_u32 s34, s24, 159744
    buffer_load_dwordx4 v[124:127], v1, s[4:7], s34 offen offset:0 nt
    s_or_b32 s24, s24, 0x6ffff
    s_add_u32 s24, s24, 1
    s_bitcmp1_b32 s24, 21
    s_cselect_b32 s4, s44, s4
    s_cselect_b32 s5, s45, s5
    s_and_b32 s24, s24, 0x190000
    v_mfma_f32_16x16x32_bf16 v[10:13], v[32:35], v[96:99], v[10:13]
    v_and_b32_dpp v32, v192, v6 row_newbcast:10 row_mask:0xf bank_mask:0xf
    v_and_b32_dpp v33, v192, v7 row_newbcast:10 row_mask:0xf bank_mask:0xf
    v_and_b32_dpp v34, v192, v8 row_newbcast:10 row_mask:0xf bank_mask:0xf
    v_and_b32_dpp v35, v192, v9 row_newbcast:10 row_mask:0xf bank_mask:0xf
    s_waitcnt vmcnt(4)
    buffer_load_dwordx4 v[128:131], v1, s[8:11], s30 offen offset:0 nt
    v_mfma_f32_16x16x32_bf16 v[10:13], v[36:39], v[100:103], v[10:13]
    v_and_b32_dpp v36, v192, v6 row_newbcast:11 row_mask:0xf bank_mask:0xf
    v_and_b32_dpp v37, v192, v7 row_newbcast:11 row_mask:0xf bank_mask:0xf
    v_and_b32_dpp v38, v192, v8 row_newbcast:11 row_mask:0xf bank_mask:0xf
    v_and_b32_dpp v39, v192, v9 row_newbcast:11 row_mask:0xf bank_mask:0xf
    s_waitcnt vmcnt(4)
    s_add_u32 s34, s30, 4096
    buffer_load_dwordx4 v[132:135], v1, s[8:11], s34 offen offset:0 nt
    v_mfma_f32_16x16x32_bf16 v[10:13], v[32:35], v[104:107], v[10:13]
    v_and_b32_dpp v32, v192, v6 row_newbcast:12 row_mask:0xf bank_mask:0xf
    v_and_b32_dpp v33, v192, v7 row_newbcast:12 row_mask:0xf bank_mask:0xf
    v_and_b32_dpp v34, v192, v8 row_newbcast:12 row_mask:0xf bank_mask:0xf
    v_and_b32_dpp v35, v192, v9 row_newbcast:12 row_mask:0xf bank_mask:0xf
    s_waitcnt vmcnt(4)
    s_add_u32 s34, s30, 8192
    buffer_load_dwordx4 v[136:139], v1, s[8:11], s34 offen offset:0 nt
    v_mfma_f32_16x16x32_bf16 v[10:13], v[36:39], v[108:111], v[10:13]
    v_and_b32_dpp v36, v192, v6 row_newbcast:13 row_mask:0xf bank_mask:0xf
    v_and_b32_dpp v37, v192, v7 row_newbcast:13 row_mask:0xf bank_mask:0xf
    v_and_b32_dpp v38, v192, v8 row_newbcast:13 row_mask:0xf bank_mask:0xf
    v_and_b32_dpp v39, v192, v9 row_newbcast:13 row_mask:0xf bank_mask:0xf
    s_waitcnt vmcnt(4)
    s_add_u32 s34, s30, 12288
    buffer_load_dwordx4 v[140:143], v1, s[8:11], s34 offen offset:0 nt
    v_mfma_f32_16x16x32_bf16 v[10:13], v[32:35], v[112:115], v[10:13]
    v_and_b32_dpp v32, v192, v6 row_newbcast:14 row_mask:0xf bank_mask:0xf
    v_and_b32_dpp v33, v192, v7 row_newbcast:14 row_mask:0xf bank_mask:0xf
    v_and_b32_dpp v34, v192, v8 row_newbcast:14 row_mask:0xf bank_mask:0xf
    v_and_b32_dpp v35, v192, v9 row_newbcast:14 row_mask:0xf bank_mask:0xf
    s_waitcnt vmcnt(4)
    s_add_u32 s34, s30, 16384
    buffer_load_dwordx4 v[144:147], v1, s[8:11], s34 offen offset:0 nt
    v_mfma_f32_16x16x32_bf16 v[10:13], v[36:39], v[116:119], v[10:13]
    v_and_b32_dpp v36, v192, v6 row_newbcast:15 row_mask:0xf bank_mask:0xf
    v_and_b32_dpp v37, v192, v7 row_newbcast:15 row_mask:0xf bank_mask:0xf
    v_and_b32_dpp v38, v192, v8 row_newbcast:15 row_mask:0xf bank_mask:0xf
    v_and_b32_dpp v39, v192, v9 row_newbcast:15 row_mask:0xf bank_mask:0xf
    s_waitcnt vmcnt(4)
    s_add_u32 s34, s30, 20480
    buffer_load_dwordx4 v[148:151], v1, s[8:11], s34 offen offset:0 nt
    v_mfma_f32_16x16x32_bf16 v[10:13], v[32:35], v[120:123], v[10:13]
    v_and_b32_dpp v32, v193, v6 row_newbcast:0 row_mask:0xf bank_mask:0xf
    v_and_b32_dpp v33, v193, v7 row_newbcast:0 row_mask:0xf bank_mask:0xf
    v_and_b32_dpp v34, v193, v8 row_newbcast:0 row_mask:0xf bank_mask:0xf
    v_and_b32_dpp v35, v193, v9 row_newbcast:0 row_mask:0xf bank_mask:0xf
    s_waitcnt vmcnt(4)
    s_add_u32 s34, s30, 24576
    buffer_load_dwordx4 v[152:155], v1, s[8:11], s34 offen offset:0 nt
    v_mfma_f32_16x16x32_bf16 v[10:13], v[36:39], v[124:127], v[10:13]
    v_and_b32_dpp v36, v193, v6 row_newbcast:1 row_mask:0xf bank_mask:0xf
    v_and_b32_dpp v37, v193, v7 row_newbcast:1 row_mask:0xf bank_mask:0xf
    v_and_b32_dpp v38, v193, v8 row_newbcast:1 row_mask:0xf bank_mask:0xf
    v_and_b32_dpp v39, v193, v9 row_newbcast:1 row_mask:0xf bank_mask:0xf
    s_waitcnt vmcnt(4)
    s_add_u32 s34, s30, 28672
    buffer_load_dwordx4 v[156:159], v1, s[8:11], s34 offen offset:0 nt
    v_mfma_f32_16x16x32_bf16 v[10:13], v[32:35], v[128:131], v[10:13]
    v_and_b32_dpp v32, v193, v6 row_newbcast:2 row_mask:0xf bank_mask:0xf
    v_and_b32_dpp v33, v193, v7 row_newbcast:2 row_mask:0xf bank_mask:0xf
    v_and_b32_dpp v34, v193, v8 row_newbcast:2 row_mask:0xf bank_mask:0xf
    v_and_b32_dpp v35, v193, v9 row_newbcast:2 row_mask:0xf bank_mask:0xf
    s_waitcnt vmcnt(4)
    s_add_u32 s34, s30, 131072
    buffer_load_dwordx4 v[160:163], v1, s[8:11], s34 offen offset:0 nt
    v_mfma_f32_16x16x32_bf16 v[10:13], v[36:39], v[132:135], v[10:13]
    v_and_b32_dpp v36, v193, v6 row_newbcast:3 row_mask:0xf bank_mask:0xf
    v_and_b32_dpp v37, v193, v7 row_newbcast:3 row_mask:0xf bank_mask:0xf
    v_and_b32_dpp v38, v193, v8 row_newbcast:3 row_mask:0xf bank_mask:0xf
    v_and_b32_dpp v39, v193, v9 row_newbcast:3 row_mask:0xf bank_mask:0xf
    s_waitcnt vmcnt(4)
    s_add_u32 s34, s30, 135168
    buffer_load_dwordx4 v[164:167], v1, s[8:11], s34 offen offset:0 nt
    v_mfma_f32_16x16x32_bf16 v[10:13], v[32:35], v[136:139], v[10:13]
    v_and_b32_dpp v32, v193, v6 row_newbcast:4 row_mask:0xf bank_mask:0xf
    v_and_b32_dpp v33, v193, v7 row_newbcast:4 row_mask:0xf bank_mask:0xf
    v_and_b32_dpp v34, v193, v8 row_newbcast:4 row_mask:0xf bank_mask:0xf
    v_and_b32_dpp v35, v193, v9 row_newbcast:4 row_mask:0xf bank_mask:0xf
    s_waitcnt vmcnt(4)
    s_add_u32 s34, s30, 139264
    buffer_load_dwordx4 v[168:171], v1, s[8:11], s34 offen offset:0 nt
    v_mfma_f32_16x16x32_bf16 v[10:13], v[36:39], v[140:143], v[10:13]
    v_and_b32_dpp v36, v193, v6 row_newbcast:5 row_mask:0xf bank_mask:0xf
    v_and_b32_dpp v37, v193, v7 row_newbcast:5 row_mask:0xf bank_mask:0xf
    v_and_b32_dpp v38, v193, v8 row_newbcast:5 row_mask:0xf bank_mask:0xf
    v_and_b32_dpp v39, v193, v9 row_newbcast:5 row_mask:0xf bank_mask:0xf
    s_waitcnt vmcnt(4)
    s_add_u32 s34, s30, 143360
    buffer_load_dwordx4 v[172:175], v1, s[8:11], s34 offen offset:0 nt
    v_mfma_f32_16x16x32_bf16 v[10:13], v[32:35], v[144:147], v[10:13]
    v_and_b32_dpp v32, v193, v6 row_newbcast:6 row_mask:0xf bank_mask:0xf
    v_and_b32_dpp v33, v193, v7 row_newbcast:6 row_mask:0xf bank_mask:0xf
    v_and_b32_dpp v34, v193, v8 row_newbcast:6 row_mask:0xf bank_mask:0xf
    v_and_b32_dpp v35, v193, v9 row_newbcast:6 row_mask:0xf bank_mask:0xf
    s_waitcnt vmcnt(4)
    s_add_u32 s34, s30, 147456
    buffer_load_dwordx4 v[176:179], v1, s[8:11], s34 offen offset:0 nt
    v_mfma_f32_16x16x32_bf16 v[10:13], v[36:39], v[148:151], v[10:13]
    v_and_b32_dpp v36, v193, v6 row_newbcast:7 row_mask:0xf bank_mask:0xf
    v_and_b32_dpp v37, v193, v7 row_newbcast:7 row_mask:0xf bank_mask:0xf
    v_and_b32_dpp v38, v193, v8 row_newbcast:7 row_mask:0xf bank_mask:0xf
    v_and_b32_dpp v39, v193, v9 row_newbcast:7 row_mask:0xf bank_mask:0xf
    s_waitcnt vmcnt(4)
    s_add_u32 s34, s30, 151552
    buffer_load_dwordx4 v[180:183], v1, s[8:11], s34 offen offset:0 nt
    v_mfma_f32_16x16x32_bf16 v[10:13], v[32:35], v[152:155], v[10:13]
    v_and_b32_dpp v32, v193, v6 row_newbcast:8 row_mask:0xf bank_mask:0xf
    v_and_b32_dpp v33, v193, v7 row_newbcast:8 row_mask:0xf bank_mask:0xf
    v_and_b32_dpp v34, v193, v8 row_newbcast:8 row_mask:0xf bank_mask:0xf
    v_and_b32_dpp v35, v193, v9 row_newbcast:8 row_mask:0xf bank_mask:0xf
    s_waitcnt vmcnt(4)
    s_add_u32 s34, s30, 155648
    buffer_load_dwordx4 v[184:187], v1, s[8:11], s34 offen offset:0 nt
    v_mfma_f32_16x16x32_bf16 v[10:13], v[36:39], v[156:159], v[10:13]
    v_and_b32_dpp v36, v193, v6 row_newbcast:9 row_mask:0xf bank_mask:0xf
    v_and_b32_dpp v37, v193, v7 row_newbcast:9 row_mask:0xf bank_mask:0xf
    v_and_b32_dpp v38, v193, v8 row_newbcast:9 row_mask:0xf bank_mask:0xf
    v_and_b32_dpp v39, v193, v9 row_newbcast:9 row_mask:0xf bank_mask:0xf
    s_waitcnt vmcnt(4)
    s_add_u32 s34, s30, 159744
    buffer_load_dwordx4 v[188:191], v1, s[8:11], s34 offen offset:0 nt
    s_or_b32 s30, s30, 0x6ffff
    s_add_u32 s30, s30, 1
    s_bitcmp1_b32 s30, 21
    s_cselect_b32 s8, s44, s8
    s_cselect_b32 s9, s45, s9
    s_and_b32 s30, s30, 0x190000
    s_or_b32 s30, s30, 0x40000
    v_mfma_f32_16x16x32_bf16 v[10:13], v[32:35], v[160:163], v[10:13]
    v_and_b32_dpp v32, v193, v6 row_newbcast:10 row_mask:0xf bank_mask:0xf
    v_and_b32_dpp v33, v193, v7 row_newbcast:10 row_mask:0xf bank_mask:0xf
    v_and_b32_dpp v34, v193, v8 row_newbcast:10 row_mask:0xf bank_mask:0xf
    v_and_b32_dpp v35, v193, v9 row_newbcast:10 row_mask:0xf bank_mask:0xf
    s_waitcnt vmcnt(6)
    v_mfma_f32_16x16x32_bf16 v[10:13], v[36:39], v[164:167], v[10:13]
    v_and_b32_dpp v36, v193, v6 row_newbcast:11 row_mask:0xf bank_mask:0xf
    v_and_b32_dpp v37, v193, v7 row_newbcast:11 row_mask:0xf bank_mask:0xf
    v_and_b32_dpp v38, v193, v8 row_newbcast:11 row_mask:0xf bank_mask:0xf
    v_and_b32_dpp v39, v193, v9 row_newbcast:11 row_mask:0xf bank_mask:0xf
    s_waitcnt vmcnt(5)
    v_mfma_f32_16x16x32_bf16 v[10:13], v[32:35], v[168:171], v[10:13]
    v_and_b32_dpp v32, v193, v6 row_newbcast:12 row_mask:0xf bank_mask:0xf
    v_and_b32_dpp v33, v193, v7 row_newbcast:12 row_mask:0xf bank_mask:0xf
    v_and_b32_dpp v34, v193, v8 row_newbcast:12 row_mask:0xf bank_mask:0xf
    v_and_b32_dpp v35, v193, v9 row_newbcast:12 row_mask:0xf bank_mask:0xf
    s_waitcnt vmcnt(4)
    v_mfma_f32_16x16x32_bf16 v[10:13], v[36:39], v[172:175], v[10:13]
    v_and_b32_dpp v36, v193, v6 row_newbcast:13 row_mask:0xf bank_mask:0xf
    v_and_b32_dpp v37, v193, v7 row_newbcast:13 row_mask:0xf bank_mask:0xf
    v_and_b32_dpp v38, v193, v8 row_newbcast:13 row_mask:0xf bank_mask:0xf
    v_and_b32_dpp v39, v193, v9 row_newbcast:13 row_mask:0xf bank_mask:0xf
    s_waitcnt vmcnt(3)
    v_mfma_f32_16x16x32_bf16 v[10:13], v[32:35], v[176:179], v[10:13]
    v_and_b32_dpp v32, v193, v6 row_newbcast:14 row_mask:0xf bank_mask:0xf
    v_and_b32_dpp v33, v193, v7 row_newbcast:14 row_mask:0xf bank_mask:0xf
    v_and_b32_dpp v34, v193, v8 row_newbcast:14 row_mask:0xf bank_mask:0xf
    v_and_b32_dpp v35, v193, v9 row_newbcast:14 row_mask:0xf bank_mask:0xf
    s_waitcnt vmcnt(2)
    v_mfma_f32_16x16x32_bf16 v[10:13], v[36:39], v[180:183], v[10:13]
    v_and_b32_dpp v36, v193, v6 row_newbcast:15 row_mask:0xf bank_mask:0xf
    v_and_b32_dpp v37, v193, v7 row_newbcast:15 row_mask:0xf bank_mask:0xf
    v_and_b32_dpp v38, v193, v8 row_newbcast:15 row_mask:0xf bank_mask:0xf
    v_and_b32_dpp v39, v193, v9 row_newbcast:15 row_mask:0xf bank_mask:0xf
    s_waitcnt vmcnt(1)
    v_mfma_f32_16x16x32_bf16 v[10:13], v[32:35], v[184:187], v[10:13]
    s_waitcnt vmcnt(0)
    s_nop 0
    v_mfma_f32_16x16x32_bf16 v[10:13], v[36:39], v[188:191], v[10:13]
    s_branch L_send
L_w2:
    v_and_b32_dpp v32, v192, v6 row_newbcast:0 row_mask:0xf bank_mask:0xf
    v_and_b32_dpp v33, v192, v7 row_newbcast:0 row_mask:0xf bank_mask:0xf
    v_and_b32_dpp v34, v192, v8 row_newbcast:0 row_mask:0xf bank_mask:0xf
    v_and_b32_dpp v35, v192, v9 row_newbcast:0 row_mask:0xf bank_mask:0xf
    v_and_b32_dpp v36, v192, v6 row_newbcast:1 row_mask:0xf bank_mask:0xf
    v_and_b32_dpp v37, v192, v7 row_newbcast:1 row_mask:0xf bank_mask:0xf
    v_and_b32_dpp v38, v192, v8 row_newbcast:1 row_mask:0xf bank_mask:0xf
    v_and_b32_dpp v39, v192, v9 row_newbcast:1 row_mask:0xf bank_mask:0xf
    s_waitcnt vmcnt(6)
    s_add_u32 s34, s24, 28672
    buffer_load_dwordx4 v[92:95], v1, s[4:7], s34 offen offset:0 nt
    v_mfma_f32_16x16x32_bf16 v[10:13], v[32:35], v[64:67], v[10:13]
    v_and_b32_dpp v32, v192, v6 row_newbcast:2 row_mask:0xf bank_mask:0xf
    v_and_b32_dpp v33, v192, v7 row_newbcast:2 row_mask:0xf bank_mask:0xf
    v_and_b32_dpp v34, v192, v8 row_newbcast:2 row_mask:0xf bank_mask:0xf
    v_and_b32_dpp v35, v192, v9 row_newbcast:2 row_mask:0xf bank_mask:0xf
    s_waitcnt vmcnt(6)
    s_add_u32 s34, s24, 131072
    buffer_load_dwordx4 v[96:99], v1, s[4:7], s34 offen offset:0 nt
    v_mfma_f32_16x16x32_bf16 v[10:13], v[36:39], v[68:71], v[10:13]
    v_and_b32_dpp v36, v192, v6 row_newbcast:3 row_mask:0xf bank_mask:0xf
    v_and_b32_dpp v37, v192, v7 row_newbcast:3 row_mask:0xf bank_mask:0xf
    v_and_b32_dpp v38, v192, v8 row_newbcast:3 row_mask:0xf bank_mask:0xf
    v_and_b32_dpp v39, v192, v9 row_newbcast:3 row_mask:0xf bank_mask:0xf
    s_waitcnt vmcnt(6)
    s_add_u32 s34, s24, 135168
    buffer_load_dwordx4 v[100:103], v1, s[4:7], s34 offen offset:0 nt
    v_mfma_f32_16x16x32_bf16 v[10:13], v[32:35], v[72:75], v[10:13]
    v_and_b32_dpp v32, v192, v6 row_newbcast:4 row_mask:0xf bank_mask:0xf
    v_and_b32_dpp v33, v192, v7 row_newbcast:4 row_mask:0xf bank_mask:0xf
    v_and_b32_dpp v34, v192, v8 row_newbcast:4 row_mask:0xf bank_mask:0xf
    v_and_b32_dpp v35, v192, v9 row_newbcast:4 row_mask:0xf bank_mask:0xf
    s_waitcnt vmcnt(6)
    s_add_u32 s34, s24, 139264
    buffer_load_dwordx4 v[104:107], v1, s[4:7], s34 offen offset:0 nt
    v_mfma_f32_16x16x32_bf16 v[10:13], v[36:39], v[76:79], v[10:13]
    v_and_b32_dpp v36, v192, v6 row_newbcast:5 row_mask:0xf bank_mask:0xf
    v_and_b32_dpp v37, v192, v7 row_newbcast:5 row_mask:0xf bank_mask:0xf
    v_and_b32_dpp v38, v192, v8 row_newbcast:5 row_mask:0xf bank_mask:0xf
    v_and_b32_dpp v39, v192, v9 row_newbcast:5 row_mask:0xf bank_mask:0xf
    s_waitcnt vmcnt(6)
    s_add_u32 s34, s24, 143360
    buffer_load_dwordx4 v[108:111], v1, s[4:7], s34 offen offset:0 nt
    v_mfma_f32_16x16x32_bf16 v[10:13], v[32:35], v[80:83], v[10:13]
    v_and_b32_dpp v32, v192, v6 row_newbcast:6 row_mask:0xf bank_mask:0xf
    v_and_b32_dpp v33, v192, v7 row_newbcast:6 row_mask:0xf bank_mask:0xf
    v_and_b32_dpp v34, v192, v8 row_newbcast:6 row_mask:0xf bank_mask:0xf
    v_and_b32_dpp v35, v192, v9 row_newbcast:6 row_mask:0xf bank_mask:0xf
    s_waitcnt vmcnt(6)
    s_add_u32 s34, s24, 147456
    buffer_load_dwordx4 v[112:115], v1, s[4:7], s34 offen offset:0 nt
    v_mfma_f32_16x16x32_bf16 v[10:13], v[36:39], v[84:87], v[10:13]
    v_and_b32_dpp v36, v192, v6 row_newbcast:7 row_mask:0xf bank_mask:0xf
    v_and_b32_dpp v37, v192, v7 row_newbcast:7 row_mask:0xf bank_mask:0xf
    v_and_b32_dpp v38, v192, v8 row_newbcast:7 row_mask:0xf bank_mask:0xf
    v_and_b32_dpp v39, v192, v9 row_newbcast:7 row_mask:0xf bank_mask:0xf
    s_waitcnt vmcnt(6)
    s_add_u32 s34, s24, 151552
    buffer_load_dwordx4 v[116:119], v1, s[4:7], s34 offen offset:0 nt
    v_mfma_f32_16x16x32_bf16 v[10:13], v[32:35], v[88:91], v[10:13]
    v_and_b32_dpp v32, v192, v6 row_newbcast:8 row_mask:0xf bank_mask:0xf
    v_and_b32_dpp v33, v192, v7 row_newbcast:8 row_mask:0xf bank_mask:0xf
    v_and_b32_dpp v34, v192, v8 row_newbcast:8 row_mask:0xf bank_mask:0xf
    v_and_b32_dpp v35, v192, v9 row_newbcast:8 row_mask:0xf bank_mask:0xf
    s_waitcnt vmcnt(6)
    s_add_u32 s34, s24, 155648
    buffer_load_dwordx4 v[120:123], v1, s[4:7], s34 offen offset:0 nt
    v_mfma_f32_16x16x32_bf16 v[10:13], v[36:39], v[92:95], v[10:13]
    v_and_b32_dpp v36, v192, v6 row_newbcast:9 row_mask:0xf bank_mask:0xf
    v_and_b32_dpp v37, v192, v7 row_newbcast:9 row_mask:0xf bank_mask:0xf
    v_and_b32_dpp v38, v192, v8 row_newbcast:9 row_mask:0xf bank_mask:0xf
    v_and_b32_dpp v39, v192, v9 row_newbcast:9 row_mask:0xf bank_mask:0xf
    s_waitcnt vmcnt(6)
    s_add_u32 s34, s24, 159744
    buffer_load_dwordx4 v[124:127], v1, s[4:7], s34 offen offset:0 nt
    s_or_b32 s24, s24, 0x6ffff
    s_add_u32 s24, s24, 1
    s_bitcmp1_b32 s24, 21
    s_cselect_b32 s4, s44, s4
    s_cselect_b32 s5, s45, s5
    s_and_b32 s24, s24, 0x190000
    v_mfma_f32_16x16x32_bf16 v[10:13], v[32:35], v[96:99], v[10:13]
    v_and_b32_dpp v32, v192, v6 row_newbcast:10 row_mask:0xf bank_mask:0xf
    v_and_b32_dpp v33, v192, v7 row_newbcast:10 row_mask:0xf bank_mask:0xf
    v_and_b32_dpp v34, v192, v8 row_newbcast:10 row_mask:0xf bank_mask:0xf
    v_and_b32_dpp v35, v192, v9 row_newbcast:10 row_mask:0xf bank_mask:0xf
    s_waitcnt vmcnt(6)
    buffer_load_dwordx4 v[128:131], v1, s[8:11], s30 offen offset:0 nt
    v_mfma_f32_16x16x32_bf16 v[10:13], v[36:39], v[100:103], v[10:13]
    v_and_b32_dpp v36, v192, v6 row_newbcast:11 row_mask:0xf bank_mask:0xf
    v_and_b32_dpp v37, v192, v7 row_newbcast:11 row_mask:0xf bank_mask:0xf
    v_and_b32_dpp v38, v192, v8 row_newbcast:11 row_mask:0xf bank_mask:0xf
    v_and_b32_dpp v39, v192, v9 row_newbcast:11 row_mask:0xf bank_mask:0xf
    s_waitcnt vmcnt(6)
    s_add_u32 s34, s30, 4096
    buffer_load_dwordx4 v[132:135], v1, s[8:11], s34 offen offset:0 nt
    v_mfma_f32_16x16x32_bf16 v[10:13], v[32:35], v[104:107], v[10:13]
    v_and_b32_dpp v32, v192, v6 row_newbcast:12 row_mask:0xf bank_mask:0xf
    v_and_b32_dpp v33, v192, v7 row_newbcast:12 row_mask:0xf bank_mask:0xf
    v_and_b32_dpp v34, v192, v8 row_newbcast:12 row_mask:0xf bank_mask:0xf
    v_and_b32_dpp v35, v192, v9 row_newbcast:12 row_mask:0xf bank_mask:0xf
    s_waitcnt vmcnt(6)
    s_add_u32 s34, s30, 8192
    buffer_load_dwordx4 v[136:139], v1, s[8:11], s34 offen offset:0 nt
    v_mfma_f32_16x16x32_bf16 v[10:13], v[36:39], v[108:111], v[10:13]
    v_and_b32_dpp v36, v192, v6 row_newbcast:13 row_mask:0xf bank_mask:0xf
    v_and_b32_dpp v37, v192, v7 row_newbcast:13 row_mask:0xf bank_mask:0xf
    v_and_b32_dpp v38, v192, v8 row_newbcast:13 row_mask:0xf bank_mask:0xf
    v_and_b32_dpp v39, v192, v9 row_newbcast:13 row_mask:0xf bank_mask:0xf
    s_waitcnt vmcnt(6)
    s_add_u32 s34, s30, 12288
    buffer_load_dwordx4 v[140:143], v1, s[8:11], s34 offen offset:0 nt
    v_mfma_f32_16x16x32_bf16 v[10:13], v[32:35], v[112:115], v[10:13]
    v_and_b32_dpp v32, v192, v6 row_newbcast:14 row_mask:0xf bank_mask:0xf
    v_and_b32_dpp v33, v192, v7 row_newbcast:14 row_mask:0xf bank_mask:0xf
    v_and_b32_dpp v34, v192, v8 row_newbcast:14 row_mask:0xf bank_mask:0xf
    v_and_b32_dpp v35, v192, v9 row_newbcast:14 row_mask:0xf bank_mask:0xf
    s_waitcnt vmcnt(6)
    s_add_u32 s34, s30, 16384
    buffer_load_dwordx4 v[144:147], v1, s[8:11], s34 offen offset:0 nt
    v_mfma_f32_16x16x32_bf16 v[10:13], v[36:39], v[116:119], v[10:13]
    v_and_b32_dpp v36, v192, v6 row_newbcast:15 row_mask:0xf bank_mask:0xf
    v_and_b32_dpp v37, v192, v7 row_newbcast:15 row_mask:0xf bank_mask:0xf
    v_and_b32_dpp v38, v192, v8 row_newbcast:15 row_mask:0xf bank_mask:0xf
    v_and_b32_dpp v39, v192, v9 row_newbcast:15 row_mask:0xf bank_mask:0xf
    s_waitcnt vmcnt(6)
    s_add_u32 s34, s30, 20480
    buffer_load_dwordx4 v[148:151], v1, s[8:11], s34 offen offset:0 nt
    v_mfma_f32_16x16x32_bf16 v[10:13], v[32:35], v[120:123], v[10:13]
    v_and_b32_dpp v32, v193, v6 row_newbcast:0 row_mask:0xf bank_mask:0xf
    v_and_b32_dpp v33, v193, v7 row_newbcast:0 row_mask:0xf bank_mask:0xf
    v_and_b32_dpp v34, v193, v8 row_newbcast:0 row_mask:0xf bank_mask:0xf
    v_and_b32_dpp v35, v193, v9 row_newbcast:0 row_mask:0xf bank_mask:0xf
    s_waitcnt vmcnt(6)
    s_add_u32 s34, s30, 24576
    buffer_load_dwordx4 v[152:155], v1, s[8:11], s34 offen offset:0 nt
    v_mfma_f32_16x16x32_bf16 v[10:13], v[36:39], v[124:127], v[10:13]
    v_and_b32_dpp v36, v193, v6 row_newbcast:1 row_mask:0xf bank_mask:0xf
    v_and_b32_dpp v37, v193, v7 row_newbcast:1 row_mask:0xf bank_mask:0xf
    v_and_b32_dpp v38, v193, v8 row_newbcast:1 row_mask:0xf bank_mask:0xf
    v_and_b32_dpp v39, v193, v9 row_newbcast:1 row_mask:0xf bank_mask:0xf
    s_waitcnt vmcnt(6)
    s_add_u32 s34, s30, 28672
    buffer_load_dwordx4 v[156:159], v1, s[8:11], s34 offen offset:0 nt
    v_mfma_f32_16x16x32_bf16 v[10:13], v[32:35], v[128:131], v[10:13]
    v_and_b32_dpp v32, v193, v6 row_newbcast:2 row_mask:0xf bank_mask:0xf
    v_and_b32_dpp v33, v193, v7 row_newbcast:2 row_mask:0xf bank_mask:0xf
    v_and_b32_dpp v34, v193, v8 row_newbcast:2 row_mask:0xf bank_mask:0xf
    v_and_b32_dpp v35, v193, v9 row_newbcast:2 row_mask:0xf bank_mask:0xf
    s_waitcnt vmcnt(6)
    s_add_u32 s34, s30, 131072
    buffer_load_dwordx4 v[160:163], v1, s[8:11], s34 offen offset:0 nt
    v_mfma_f32_16x16x32_bf16 v[10:13], v[36:39], v[132:135], v[10:13]
    v_and_b32_dpp v36, v193, v6 row_newbcast:3 row_mask:0xf bank_mask:0xf
    v_and_b32_dpp v37, v193, v7 row_newbcast:3 row_mask:0xf bank_mask:0xf
    v_and_b32_dpp v38, v193, v8 row_newbcast:3 row_mask:0xf bank_mask:0xf
    v_and_b32_dpp v39, v193, v9 row_newbcast:3 row_mask:0xf bank_mask:0xf
    s_waitcnt vmcnt(6)
    s_add_u32 s34, s30, 135168
    buffer_load_dwordx4 v[164:167], v1, s[8:11], s34 offen offset:0 nt
    v_mfma_f32_16x16x32_bf16 v[10:13], v[32:35], v[136:139], v[10:13]
    v_and_b32_dpp v32, v193, v6 row_newbcast:4 row_mask:0xf bank_mask:0xf
    v_and_b32_dpp v33, v193, v7 row_newbcast:4 row_mask:0xf bank_mask:0xf
    v_and_b32_dpp v34, v193, v8 row_newbcast:4 row_mask:0xf bank_mask:0xf
    v_and_b32_dpp v35, v193, v9 row_newbcast:4 row_mask:0xf bank_mask:0xf
    s_waitcnt vmcnt(6)
    s_add_u32 s34, s30, 139264
    buffer_load_dwordx4 v[168:171], v1, s[8:11], s34 offen offset:0 nt
    v_mfma_f32_16x16x32_bf16 v[10:13], v[36:39], v[140:143], v[10:13]
    v_and_b32_dpp v36, v193, v6 row_newbcast:5 row_mask:0xf bank_mask:0xf
    v_and_b32_dpp v37, v193, v7 row_newbcast:5 row_mask:0xf bank_mask:0xf
    v_and_b32_dpp v38, v193, v8 row_newbcast:5 row_mask:0xf bank_mask:0xf
    v_and_b32_dpp v39, v193, v9 row_newbcast:5 row_mask:0xf bank_mask:0xf
    s_waitcnt vmcnt(6)
    s_add_u32 s34, s30, 143360
    buffer_load_dwordx4 v[172:175], v1, s[8:11], s34 offen offset:0 nt
    v_mfma_f32_16x16x32_bf16 v[10:13], v[32:35], v[144:147], v[10:13]
    v_and_b32_dpp v32, v193, v6 row_newbcast:6 row_mask:0xf bank_mask:0xf
    v_and_b32_dpp v33, v193, v7 row_newbcast:6 row_mask:0xf bank_mask:0xf
    v_and_b32_dpp v34, v193, v8 row_newbcast:6 row_mask:0xf bank_mask:0xf
    v_and_b32_dpp v35, v193, v9 row_newbcast:6 row_mask:0xf bank_mask:0xf
    s_waitcnt vmcnt(6)
    s_add_u32 s34, s30, 147456
    buffer_load_dwordx4 v[176:179], v1, s[8:11], s34 offen offset:0 nt
    v_mfma_f32_16x16x32_bf16 v[10:13], v[36:39], v[148:151], v[10:13]
    v_and_b32_dpp v36, v193, v6 row_newbcast:7 row_mask:0xf bank_mask:0xf
    v_and_b32_dpp v37, v193, v7 row_newbcast:7 row_mask:0xf bank_mask:0xf
    v_and_b32_dpp v38, v193, v8 row_newbcast:7 row_mask:0xf bank_mask:0xf
    v_and_b32_dpp v39, v193, v9 row_newbcast:7 row_mask:0xf bank_mask:0xf
    s_waitcnt vmcnt(6)
    s_add_u32 s34, s30, 151552
    buffer_load_dwordx4 v[180:183], v1, s[8:11], s34 offen offset:0 nt
    v_mfma_f32_16x16x32_bf16 v[10:13], v[32:35], v[152:155], v[10:13]
    v_and_b32_dpp v32, v193, v6 row_newbcast:8 row_mask:0xf bank_mask:0xf
    v_and_b32_dpp v33, v193, v7 row_newbcast:8 row_mask:0xf bank_mask:0xf
    v_and_b32_dpp v34, v193, v8 row_newbcast:8 row_mask:0xf bank_mask:0xf
    v_and_b32_dpp v35, v193, v9 row_newbcast:8 row_mask:0xf bank_mask:0xf
    s_waitcnt vmcnt(6)
    s_add_u32 s34, s30, 155648
    buffer_load_dwordx4 v[184:187], v1, s[8:11], s34 offen offset:0 nt
    v_mfma_f32_16x16x32_bf16 v[10:13], v[36:39], v[156:159], v[10:13]
    v_and_b32_dpp v36, v193, v6 row_newbcast:9 row_mask:0xf bank_mask:0xf
    v_and_b32_dpp v37, v193, v7 row_newbcast:9 row_mask:0xf bank_mask:0xf
    v_and_b32_dpp v38, v193, v8 row_newbcast:9 row_mask:0xf bank_mask:0xf
    v_and_b32_dpp v39, v193, v9 row_newbcast:9 row_mask:0xf bank_mask:0xf
    s_waitcnt vmcnt(6)
    s_add_u32 s34, s30, 159744
    buffer_load_dwordx4 v[188:191], v1, s[8:11], s34 offen offset:0 nt
    s_or_b32 s30, s30, 0x6ffff
    s_add_u32 s30, s30, 1
    s_bitcmp1_b32 s30, 21
    s_cselect_b32 s8, s44, s8
    s_cselect_b32 s9, s45, s9
    s_and_b32 s30, s30, 0x190000
    s_or_b32 s30, s30, 0x40000
    v_mfma_f32_16x16x32_bf16 v[10:13], v[32:35], v[160:163], v[10:13]
    v_and_b32_dpp v32, v193, v6 row_newbcast:10 row_mask:0xf bank_mask:0xf
    v_and_b32_dpp v33, v193, v7 row_newbcast:10 row_mask:0xf bank_mask:0xf
    v_and_b32_dpp v34, v193, v8 row_newbcast:10 row_mask:0xf bank_mask:0xf
    v_and_b32_dpp v35, v193, v9 row_newbcast:10 row_mask:0xf bank_mask:0xf
    s_waitcnt vmcnt(6)
    v_mfma_f32_16x16x32_bf16 v[10:13], v[36:39], v[164:167], v[10:13]
    v_and_b32_dpp v36, v193, v6 row_newbcast:11 row_mask:0xf bank_mask:0xf
    v_and_b32_dpp v37, v193, v7 row_newbcast:11 row_mask:0xf bank_mask:0xf
    v_and_b32_dpp v38, v193, v8 row_newbcast:11 row_mask:0xf bank_mask:0xf
    v_and_b32_dpp v39, v193, v9 row_newbcast:11 row_mask:0xf bank_mask:0xf
    s_waitcnt vmcnt(5)
    v_mfma_f32_16x16x32_bf16 v[10:13], v[32:35], v[168:171], v[10:13]
    v_and_b32_dpp v32, v193, v6 row_newbcast:12 row_mask:0xf bank_mask:0xf
    v_and_b32_dpp v33, v193, v7 row_newbcast:12 row_mask:0xf bank_mask:0xf
    v_and_b32_dpp v34, v193, v8 row_newbcast:12 row_mask:0xf bank_mask:0xf
    v_and_b32_dpp v35, v193, v9 row_newbcast:12 row_mask:0xf bank_mask:0xf
    s_waitcnt vmcnt(4)
    v_mfma_f32_16x16x32_bf16 v[10:13], v[36:39], v[172:175], v[10:13]
    v_and_b32_dpp v36, v193, v6 row_newbcast:13 row_mask:0xf bank_mask:0xf
    v_and_b32_dpp v37, v193, v7 row_newbcast:13 row_mask:0xf bank_mask:0xf
    v_and_b32_dpp v38, v193, v8 row_newbcast:13 row_mask:0xf bank_mask:0xf
    v_and_b32_dpp v39, v193, v9 row_newbcast:13 row_mask:0xf bank_mask:0xf
    s_waitcnt vmcnt(3)
    v_mfma_f32_16x16x32_bf16 v[10:13], v[32:35], v[176:179], v[10:13]
    v_and_b32_dpp v32, v193, v6 row_newbcast:14 row_mask:0xf bank_mask:0xf
    v_and_b32_dpp v33, v193, v7 row_newbcast:14 row_mask:0xf bank_mask:0xf
    v_and_b32_dpp v34, v193, v8 row_newbcast:14 row_mask:0xf bank_mask:0xf
    v_and_b32_dpp v35, v193, v9 row_newbcast:14 row_mask:0xf bank_mask:0xf
    s_waitcnt vmcnt(2)
    v_mfma_f32_16x16x32_bf16 v[10:13], v[36:39], v[180:183], v[10:13]
    v_and_b32_dpp v36, v193, v6 row_newbcast:15 row_mask:0xf bank_mask:0xf
    v_and_b32_dpp v37, v193, v7 row_newbcast:15 row_mask:0xf bank_mask:0xf
    v_and_b32_dpp v38, v193, v8 row_newbcast:15 row_mask:0xf bank_mask:0xf
    v_and_b32_dpp v39, v193, v9 row_newbcast:15 row_mask:0xf bank_mask:0xf
    s_waitcnt vmcnt(1)
    v_mfma_f32_16x16x32_bf16 v[10:13], v[32:35], v[184:187], v[10:13]
    s_waitcnt vmcnt(0)
    s_nop 0
    v_mfma_f32_16x16x32_bf16 v[10:13], v[36:39], v[188:191], v[10:13]
L_send:
    v_add_f32_dpp v14, v14, v14 quad_perm:[1,0,3,2] row_mask:0xf bank_mask:0xf
    v_lshrrev_b32 v40, 5, v0
    v_and_b32 v41, 15, v0
    v_add_f32_dpp v14, v14, v14 quad_perm:[2,3,0,1] row_mask:0xf bank_mask:0xf
    v_lshl_add_u32 v40, v40, 4, v41
    v_and_b32 v41, 16, v0
    v_add_f32_dpp v14, v14, v14 row_half_mirror row_mask:0xf bank_mask:0xf
    v_lshl_add_u32 v40, v40, 5, v41
    s_lshl_b32 s33, s26, 10
    v_add_f32_dpp v14, v14, v14 row_ror:8 row_mask:0xf bank_mask:0xf
    v_add_u32 v40, s33, v40
    v_mov_b32 v49, v14
    s_lshl_b32 s33, s26, 3
    v_mov_b32 v41, s33
    v_permlane32_swap_b32 v14, v49
    ds_write_b128 v40, v[10:13] offset:4096
    v_add_f32 v49, v14, v49
    ds_write_b64 v41, v[48:49] offset:8192
    s_waitcnt lgkmcnt(0)
    s_barrier

    s_cmp_lg_u32 s26, 0
    s_cbranch_scc1 L_end
    v_mov_b32 v1, 8260
    ds_read_b32 v1, v1
    v_and_b32 v2, 3, v0
    v_lshrrev_b32 v3, 2, v0
    v_lshlrev_b32 v3, 11, v3
    v_lshl_add_u32 v3, v2, 4, v3
    v_lshrrev_b32 v6, 4, v0
    v_lshl_add_u32 v2, v2, 2, v6
    s_lshl_b32 s33, s31, 3
    s_and_b32 s33, s33, 8
    v_lshl_add_u32 v6, v2, 2, s33
    v_add_u32 v6, 8192, v6
    ds_read2_b32 v[4:5], v6 offset0:32 offset1:48
    v_and_b32 v6, 12, v0
    v_cmp_gt_u32 vcc, 14, v2
    v_cmp_eq_u32 s[38:39], 0, v6
    v_lshlrev_b32 v2, 1, v2
    s_and_b64 s[38:39], s[38:39], vcc
    s_lshl_b32 s33, s27, 16
    s_lshl_b32 s34, s31, 6
    s_add_u32 s33, s33, s34
    s_add_u32 s33, s33, 1572864
    s_add_u32 s24, s33, 32768
    s_mul_i32 s34, s27, 896
    s_mul_i32 s35, s31, 28
    s_add_u32 s34, s34, s35
    s_mov_b32 s12, s58
    s_mov_b32 s13, s59
    s_mov_b32 s14, 7168
    s_mov_b32 s15, 0x20000
    s_mov_b32 s35, 524288
    s_waitcnt lgkmcnt(0)
    v_readfirstlane_b32 s65, v1
    s_and_b32 s65, s65, 0x3ff
    s_mov_b32 s66, 0xffffffff
    s_mov_b32 s67, 0xffffffff
    s_mov_b32 s68, 0xffffffff
    s_mov_b32 s69, 0xffffffff
    s_mov_b32 s76, 0x8000
    s_mov_b64 exec, s[66:67]
    buffer_load_dwordx4 v[16:19], v3, s[20:23], s33 offen offset:0 sc1 nt
    s_mov_b64 exec, s[68:69]
    buffer_load_dwordx4 v[24:27], v3, s[20:23], s24 offen offset:0 sc1 nt
    s_mov_b64 exec, -1
    s_barrier
    s_branch L_g1c
L_g1:
    s_sleep 4
    s_mov_b64 exec, s[66:67]
    buffer_load_dwordx4 v[16:19], v3, s[20:23], s33 offen offset:0 sc1 nt
    s_mov_b64 exec, s[68:69]
    buffer_load_dwordx4 v[24:27], v3, s[20:23], s24 offen offset:0 sc1 nt
L_g1c:
    s_waitcnt vmcnt(0)
    s_mov_b64 exec, s[66:67]
    v_xor_b32 v16, s65, v16
    v_xor_b32 v17, s65, v17
    v_xor_b32 v18, s65, v18
    v_xor_b32 v19, s65, v19
    v_or3_b32 v7, v16, v17, v18
    v_or_b32 v7, v7, v19
    v_lshlrev_b32 v7, 22, v7
    v_cmp_ne_u32 s[66:67], 0, v7
    s_mov_b64 exec, s[68:69]
    v_xor_b32 v24, s65, v24
    v_xor_b32 v25, s65, v25
    v_xor_b32 v26, s65, v26
    v_xor_b32 v27, s65, v27
    v_or3_b32 v7, v24, v25, v26
    v_or_b32 v7, v7, v27
    v_lshlrev_b32 v7, 22, v7
    v_cmp_ne_u32 s[68:69], 0, v7
    s_mov_b64 s[74:75], s[66:67]
    s_or_b64 s[74:75], s[74:75], s[68:69]
    s_cmp_eq_u64 s[74:75], 0
    s_cbranch_scc1 L_g1d
    s_sub_u32 s76, s76, 1
    s_cbranch_scc0 L_g1
L_g1d:
    s_mov_b64 exec, -1
    v_mov_b32_dpp v20, v18 quad_perm:[3,3,3,3] row_mask:0xf bank_mask:0xf
    v_mov_b32_dpp v21, v19 quad_perm:[3,3,3,3] row_mask:0xf bank_mask:0xf
    v_mov_b32_dpp v28, v26 quad_perm:[3,3,3,3] row_mask:0xf bank_mask:0xf
    v_mov_b32_dpp v29, v27 quad_perm:[3,3,3,3] row_mask:0xf bank_mask:0xf
    v_max_f32_dpp v22, v20, v20 row_half_mirror row_mask:0xf bank_mask:0xf
    v_max_f32_dpp v30, v28, v28 row_half_mirror row_mask:0xf bank_mask:0xf
    v_sub_f32 v20, v20, v22
    v_sub_f32 v28, v28, v30
    v_mul_f32 v20, s64, v20
    v_mul_f32 v28, s64, v28
    v_exp_f32 v20, v20
    v_exp_f32 v28, v28
    v_mul_f32 v21, v21, v20
    v_mul_f32 v29, v29, v28
    s_nop 0
    v_add_f32_dpp v21, v21, v21 row_half_mirror row_mask:0xf bank_mask:0xf
    v_add_f32_dpp v29, v29, v29 row_half_mirror row_mask:0xf bank_mask:0xf
    v_rcp_f32 v21, v21
    v_rcp_f32 v29, v29
    v_mul_f32 v20, v20, v21
    v_mul_f32 v28, v28, v29
    v_mul_f32 v16, v16, v20
    v_mul_f32 v17, v17, v20
    v_mul_f32 v18, v18, v20
    v_mul_f32 v19, v19, v20
    v_fmac_f32 v16, v24, v28
    v_fmac_f32 v18, v26, v28
    v_fmac_f32 v17, v25, v28
    v_fmac_f32 v19, v27, v28
    v_permlane32_swap_b32 v16, v18
    s_nop 0
    v_permlane32_swap_b32 v17, v19
    v_add_f32 v16, v16, v18
    v_add_f32 v17, v17, v19
    s_nop 1
    v_permlane16_swap_b32 v16, v17
    v_add_f32 v16, v16, v17
    s_nop 1
    v_add_f32_dpp v16, v16, v16 row_ror:4 row_mask:0xf bank_mask:0xf
    s_nop 1
    v_add_f32_dpp v16, v16, v16 row_ror:8 row_mask:0xf bank_mask:0xf
    v_cvt_pk_bf16_f32 v16, v16, v16
    v_and_b32 v16, 0xffff0000, v16
    v_mul_f32 v16, v16, v4
    v_cvt_pk_bf16_f32 v16, v16, v16
    v_and_b32 v16, 0xffff0000, v16
    v_add_f32 v16, v16, v5
    v_cvt_pk_bf16_f32 v16, v16, v16
    s_mov_b64 exec, s[38:39]
    buffer_store_short v16, v2, s[12:15], s34 offen
    s_cmp_lg_u32 s2, 0
    s_cbranch_scc1 L_fin
    s_mov_b64 exec, 1
    buffer_store_dword v1, off, s[20:23], s35 sc1
    s_branch L_fin

L_helper:
    s_setprio 2
    s_sub_u32 s26, s26, 4
    v_lshrrev_b32 v27, 5, v0
    v_and_b32 v28, 31, v0
    v_mul_u32_u24 v29, 896, v27
    v_lshl_add_u32 v29, v28, 5, v29
    v_cmp_gt_u32 s[38:39], 28, v28
    v_lshrrev_b32 v21, 3, v0
    v_and_b32 v22, 7, v0
    v_mov_b32 v30, 0x8000
    v_lshlrev_b32 v22, 4, v22
    v_cndmask_b32 v29, v30, v29, s[38:39]
    v_lshrrev_b32 v1, 1, v0
    v_mul_u32_u24 v1, 8192, v1
    v_and_b32 v31, 16, v22
    v_add_u32 v1, v1, v31
    s_mul_i32 s33, s26, 1792
    s_mov_b32 s35, 524288
    s_waitcnt lgkmcnt(0)
    s_mov_b32 s20, s62
    s_mov_b32 s21, s63
    s_mov_b32 s16, s40
    s_mov_b32 s17, s41
    s_mov_b32 s18, 7168
    s_mov_b32 s19, 0x20000
    buffer_load_dwordx4 v[32:35], v29, s[16:19], s33 offen nt
    buffer_load_dwordx4 v[36:39], v29, s[16:19], s33 offen offset:16 nt
    buffer_load_dword v18, off, s[20:23], s35 sc1 nt
    s_mov_b32 s12, s46
    s_mov_b32 s13, s47
    s_mov_b32 s14, 3670016
    s_mov_b32 s15, 0x20000
    s_lshl_b32 s33, s28, 9
    s_lshl_b32 s34, s25, 5
    s_add_u32 s33, s33, s34
    s_mul_i32 s34, s26, 262144
    s_add_u32 s35, s33, s34
    s_lshl_b32 s34, s26, 10
    s_add_u32 m0, s34, 24576
    s_nop 0
    buffer_load_dwordx4 v1, s[12:15], s35 offen nt lds
    s_add_u32 s35, s35, 1048576
    s_add_u32 m0, m0, 4096
    s_nop 0
    buffer_load_dwordx4 v1, s[12:15], s35 offen nt lds
    s_add_u32 s35, s35, 1048576
    s_add_u32 m0, m0, 4096
    s_nop 0
    buffer_load_dwordx4 v1, s[12:15], s35 offen nt lds
    s_add_u32 s35, s35, 1048576
    s_add_u32 m0, m0, 4096
    s_cmp_ge_u32 s26, 2
    s_cbranch_scc1 L_t2
    s_nop 0
    buffer_load_dwordx4 v1, s[12:15], s35 offen nt lds
L_t2:
    v_mov_b32 v30, 0
    v_mov_b32 v31, 8256
    ds_write_b32 v31, v30
    s_mul_i32 s34, s26, 1824
    v_mul_u32_u24 v27, 912, v27
    v_lshl_add_u32 v27, v28, 5, v27
    v_add_u32 v27, s34, v27
    s_waitcnt lgkmcnt(0)
    s_barrier
    v_and_b32 v28, 1, v0
    v_mov_b32 v29, 0xffff
    v_lshlrev_b32 v28, 4, v28
    v_lshlrev_b32 v29, v28, v29
    v_bfe_u32 v28, v0, 1, 2
    v_cmp_eq_u32 vcc, 0, v28
    s_nop 1
    v_cndmask_b32 v2, 0, v29, vcc
    v_cmp_eq_u32 vcc, 1, v28
    s_nop 1
    v_cndmask_b32 v3, 0, v29, vcc
    v_cmp_eq_u32 vcc, 2, v28
    s_nop 1
    v_cndmask_b32 v4, 0, v29, vcc
    v_cmp_eq_u32 vcc, 3, v28
    s_nop 1
    v_cndmask_b32 v5, 0, v29, vcc
    v_lshrrev_b32 v23, 5, v0
    v_lshlrev_b32 v23, 8, v23
    v_lshl_add_u32 v23, v22, 1, v23
    v_and_b32 v28, 16, v0
    v_add_u32 v23, v23, v28
    v_lshrrev_b32 v29, 4, v0
    v_and_b32 v28, 15, v0
    v_lshlrev_b32 v28, 3, v28
    v_lshl_add_u32 v24, v29, 8, v28
    v_and_b32 v28, 7, v0
    v_mul_u32_u24 v25, 912, v28
    v_lshl_add_u32 v25, v29, 4, v25
    v_and_b32 v28, 3, v0
    v_and_b32 v26, 28, v0
    v_lshl_add_u32 v26, v28, 6, v26
    s_mov_b32 s36, 0x00ff00ff
    s_mov_b32 s37, 0x00ff00ff
    s_waitcnt vmcnt(4)
    v_lshlrev_b32 v40, 16, v32
    v_and_b32 v41, 0xffff0000, v32
    v_lshlrev_b32 v42, 16, v33
    v_and_b32 v43, 0xffff0000, v33
    v_lshlrev_b32 v44, 16, v34
    v_and_b32 v45, 0xffff0000, v34
    v_lshlrev_b32 v46, 16, v35
    v_and_b32 v47, 0xffff0000, v35
    v_lshlrev_b32 v48, 16, v36
    v_and_b32 v49, 0xffff0000, v36
    v_lshlrev_b32 v50, 16, v37
    v_and_b32 v51, 0xffff0000, v37
    v_lshlrev_b32 v52, 16, v38
    v_and_b32 v53, 0xffff0000, v38
    v_lshlrev_b32 v54, 16, v39
    v_and_b32 v55, 0xffff0000, v39
    v_add_f32 v32, v40, v41
    v_add_f32 v33, v42, v43
    v_add_f32 v34, v44, v45
    v_add_f32 v35, v46, v47
    v_add_f32 v36, v48, v49
    v_add_f32 v37, v50, v51
    v_add_f32 v38, v52, v53
    v_add_f32 v39, v54, v55
    v_add_f32 v32, v32, v36
    v_add_f32 v33, v33, v37
    v_add_f32 v34, v34, v38
    v_add_f32 v35, v35, v39
    v_add_f32 v32, v32, v34
    v_add_f32 v33, v33, v35
    v_add_f32 v32, v32, v33
    s_nop 1
    v_add_f32_dpp v32, v32, v32 quad_perm:[1,0,3,2] row_mask:0xf bank_mask:0xf
    s_nop 1
    v_add_f32_dpp v32, v32, v32 quad_perm:[2,3,0,1] row_mask:0xf bank_mask:0xf
    s_nop 1
    v_add_f32_dpp v32, v32, v32 row_half_mirror row_mask:0xf bank_mask:0xf
    s_nop 1
    v_add_f32_dpp v32, v32, v32 row_ror:8 row_mask:0xf bank_mask:0xf
    v_mov_b32 v28, v32
    s_nop 1
    v_permlane16_swap_b32 v32, v28
    v_add_f32 v32, v32, v28
    v_mul_f32 v32, 0x3b124925, v32
    v_sub_f32 v56, v40, v32
    v_sub_f32 v57, v41, v32
    v_sub_f32 v58, v42, v32
    v_sub_f32 v59, v43, v32
    v_sub_f32 v60, v44, v32
    v_sub_f32 v61, v45, v32
    v_sub_f32 v62, v46, v32
    v_sub_f32 v63, v47, v32
    v_sub_f32 v64, v48, v32
    v_sub_f32 v65, v49, v32
    v_sub_f32 v66, v50, v32
    v_sub_f32 v67, v51, v32
    v_sub_f32 v68, v52, v32
    v_sub_f32 v69, v53, v32
    v_sub_f32 v70, v54, v32
    v_sub_f32 v71, v55, v32
    v_mul_f32 v33, v56, v56
    v_mul_f32 v34, v57, v57
    v_mul_f32 v35, v58, v58
    v_mul_f32 v36, v59, v59
    v_fmac_f32 v33, v60, v60
    v_fmac_f32 v34, v61, v61
    v_fmac_f32 v35, v62, v62
    v_fmac_f32 v36, v63, v63
    v_fmac_f32 v33, v64, v64
    v_fmac_f32 v34, v65, v65
    v_fmac_f32 v35, v66, v66
    v_fmac_f32 v36, v67, v67
    v_fmac_f32 v33, v68, v68
    v_fmac_f32 v34, v69, v69
    v_fmac_f32 v35, v70, v70
    v_fmac_f32 v36, v71, v71
    v_add_f32 v33, v33, v34
    v_add_f32 v35, v35, v36
    v_add_f32 v33, v33, v35
    v_cndmask_b32 v33, 0, v33, s[38:39]
    s_nop 1
    v_add_f32_dpp v33, v33, v33 quad_perm:[1,0,3,2] row_mask:0xf bank_mask:0xf
    s_nop 1
    v_add_f32_dpp v33, v33, v33 quad_perm:[2,3,0,1] row_mask:0xf bank_mask:0xf
    s_nop 1
    v_add_f32_dpp v33, v33, v33 row_half_mirror row_mask:0xf bank_mask:0xf
    s_nop 1
    v_add_f32_dpp v33, v33, v33 row_ror:8 row_mask:0xf bank_mask:0xf
    v_mov_b32 v28, v33
    s_nop 1
    v_permlane16_swap_b32 v33, v28
    v_add_f32 v33, v33, v28
    v_mul_f32 v33, 0x3b124925, v33
    v_cvt_pk_bf16_f32 v32, v32, v32
    v_and_b32 v32, 0xffff0000, v32
    v_cvt_pk_bf16_f32 v33, v33, v33
    v_and_b32 v33, 0xffff0000, v33
    v_add_f32 v33, 0x3727c5ac, v33
    v_cvt_pk_bf16_f32 v33, v33, v33
    v_and_b32 v33, 0xffff0000, v33
    v_sqrt_f32 v33, v33
    v_sub_f32 v40, v40, v32
    v_sub_f32 v41, v41, v32
    v_sub_f32 v42, v42, v32
    v_sub_f32 v43, v43, v32
    v_sub_f32 v44, v44, v32
    v_sub_f32 v45, v45, v32
    v_sub_f32 v46, v46, v32
    v_sub_f32 v47, v47, v32
    v_sub_f32 v48, v48, v32
    v_sub_f32 v49, v49, v32
    v_sub_f32 v50, v50, v32
    v_sub_f32 v51, v51, v32
    v_sub_f32 v52, v52, v32
    v_sub_f32 v53, v53, v32
    v_sub_f32 v54, v54, v32
    v_sub_f32 v55, v55, v32
    v_cvt_pk_bf16_f32 v33, v33, v33
    v_and_b32 v33, 0xffff0000, v33
    v_rcp_f32 v33, v33
    v_cvt_pk_bf16_f32 v56, v40, v41
    v_cvt_pk_bf16_f32 v57, v42, v43
    v_cvt_pk_bf16_f32 v58, v44, v45
    v_cvt_pk_bf16_f32 v59, v46, v47
    v_cvt_pk_bf16_f32 v60, v48, v49
    v_cvt_pk_bf16_f32 v61, v50, v51
    v_cvt_pk_bf16_f32 v62, v52, v53
    v_cvt_pk_bf16_f32 v63, v54, v55
    v_lshlrev_b32 v40, 16, v56
    v_and_b32 v41, 0xffff0000, v56
    v_lshlrev_b32 v42, 16, v57
    v_and_b32 v43, 0xffff0000, v57
    v_lshlrev_b32 v44, 16, v58
    v_and_b32 v45, 0xffff0000, v58
    v_lshlrev_b32 v46, 16, v59
    v_and_b32 v47, 0xffff0000, v59
    v_lshlrev_b32 v48, 16, v60
    v_and_b32 v49, 0xffff0000, v60
    v_lshlrev_b32 v50, 16, v61
    v_and_b32 v51, 0xffff0000, v61
    v_lshlrev_b32 v52, 16, v62
    v_and_b32 v53, 0xffff0000, v62
    v_lshlrev_b32 v54, 16, v63
    v_and_b32 v55, 0xffff0000, v63
    v_mul_f32 v40, v40, v33
    v_mul_f32 v41, v41, v33
    v_mul_f32 v42, v42, v33
    v_mul_f32 v43, v43, v33
    v_mul_f32 v44, v44, v33
    v_mul_f32 v45, v45, v33
    v_mul_f32 v46, v46, v33
    v_mul_f32 v47, v47, v33
    v_mul_f32 v48, v48, v33
    v_mul_f32 v49, v49, v33
    v_mul_f32 v50, v50, v33
    v_mul_f32 v51, v51, v33
    v_mul_f32 v52, v52, v33
    v_mul_f32 v53, v53, v33
    v_mul_f32 v54, v54, v33
    v_mul_f32 v55, v55, v33
    v_cvt_pk_bf16_f32 v56, v40, v41
    v_cvt_pk_bf16_f32 v57, v42, v43
    v_cvt_pk_bf16_f32 v58, v44, v45
    v_cvt_pk_bf16_f32 v59, v46, v47
    v_cvt_pk_bf16_f32 v60, v48, v49
    v_cvt_pk_bf16_f32 v61, v50, v51
    v_cvt_pk_bf16_f32 v62, v52, v53
    v_cvt_pk_bf16_f32 v63, v54, v55
    s_mov_b64 exec, s[38:39]
    ds_write_b128 v27, v[56:59] offset:8448
    ds_write_b128 v27, v[60:63] offset:8464
    s_waitcnt vmcnt(0) lgkmcnt(0)
    s_mov_b64 exec, 1
    v_mov_b32 v27, 8256
    v_mov_b32 v28, 1
    ds_add_u32 v27, v28
    s_mov_b32 s76, 0x100000
L_s3:
    ds_read_b32 v28, v27
    s_sub_u32 s76, s76, 1
    s_cbranch_scc1 L_s3d
    s_waitcnt lgkmcnt(0)
    v_readfirstlane_b32 s34, v28
    s_cmp_lt_u32 s34, 4
    s_cbranch_scc1 L_s3
L_s3d:
    s_mov_b64 exec, -1
    v_add_u32 v18, 1, v18
    s_nop 0
    v_readfirstlane_b32 s65, v18
    s_and_b32 s65, s65, 0x3ff
    s_cmp_lg_u32 s26, 0
    s_cbranch_scc1 L_b1
    ds_read_b64_tr_b16 v[40:41], v24 offset:24576
    ds_read_b64_tr_b16 v[42:43], v24 offset:24704
    ds_read_b128 v[44:47], v25 offset:8448
    ds_read_b64_tr_b16 v[48:49], v24 offset:25600
    ds_read_b64_tr_b16 v[50:51], v24 offset:25728
    ds_read_b128 v[52:55], v25 offset:8512
    ds_read_b64_tr_b16 v[56:57], v24 offset:26624
    ds_read_b64_tr_b16 v[58:59], v24 offset:26752
    ds_read_b128 v[60:63], v25 offset:8576
    ds_read_b64_tr_b16 v[64:65], v24 offset:27648
    ds_read_b64_tr_b16 v[66:67], v24 offset:27776
    ds_read_b128 v[68:71], v25 offset:8640
    ds_read_b64_tr_b16 v[72:73], v24 offset:28672
    ds_read_b64_tr_b16 v[74:75], v24 offset:28800
    ds_read_b128 v[76:79], v25 offset:8704
    s_waitcnt lgkmcnt(12)
    v_mfma_f32_16x16x32_bf16 v[32:35], v[40:43], v[44:47], 0
    ds_read_b64_tr_b16 v[80:81], v24 offset:29696
    ds_read_b64_tr_b16 v[82:83], v24 offset:29824
    ds_read_b128 v[84:87], v25 offset:8768
    s_waitcnt lgkmcnt(12)
    v_mfma_f32_16x16x32_bf16 v[32:35], v[48:51], v[52:55], v[32:35]
    ds_read_b64_tr_b16 v[40:41], v24 offset:30720
    ds_read_b64_tr_b16 v[42:43], v24 offset:30848
    ds_read_b128 v[44:47], v25 offset:8832
    s_waitcnt lgkmcnt(12)
    v_mfma_f32_16x16x32_bf16 v[32:35], v[56:59], v[60:63], v[32:35]
    ds_read_b64_tr_b16 v[48:49], v24 offset:31744
    ds_read_b64_tr_b16 v[50:51], v24 offset:31872
    ds_read_b128 v[52:55], v25 offset:8896
    s_waitcnt lgkmcnt(12)
    v_mfma_f32_16x16x32_bf16 v[32:35], v[64:67], v[68:71], v[32:35]
    ds_read_b64_tr_b16 v[56:57], v24 offset:32768
    ds_read_b64_tr_b16 v[58:59], v24 offset:32896
    ds_read_b128 v[60:63], v25 offset:8960
    s_waitcnt lgkmcnt(12)
    v_mfma_f32_16x16x32_bf16 v[32:35], v[72:75], v[76:79], v[32:35]
    ds_read_b64_tr_b16 v[64:65], v24 offset:33792
    ds_read_b64_tr_b16 v[66:67], v24 offset:33920
    ds_read_b128 v[68:71], v25 offset:9024
    s_waitcnt lgkmcnt(12)
    v_mfma_f32_16x16x32_bf16 v[32:35], v[80:83], v[84:87], v[32:35]
    ds_read_b64_tr_b16 v[72:73], v24 offset:34816
    ds_read_b64_tr_b16 v[74:75], v24 offset:34944
    ds_read_b128 v[76:79], v25 offset:9088
    s_waitcnt lgkmcnt(12)
    v_mfma_f32_16x16x32_bf16 v[32:35], v[40:43], v[44:47], v[32:35]
    ds_read_b64_tr_b16 v[80:81], v24 offset:35840
    ds_read_b64_tr_b16 v[82:83], v24 offset:35968
    ds_read_b128 v[84:87], v25 offset:9152
    s_waitcnt lgkmcnt(12)
    v_mfma_f32_16x16x32_bf16 v[32:35], v[48:51], v[52:55], v[32:35]
    ds_read_b64_tr_b16 v[40:41], v24 offset:36864
    ds_read_b64_tr_b16 v[42:43], v24 offset:36992
    ds_read_b128 v[44:47], v25 offset:9216
    s_waitcnt lgkmcnt(12)
    v_mfma_f32_16x16x32_bf16 v[32:35], v[56:59], v[60:63], v[32:35]
    ds_read_b64_tr_b16 v[48:49], v24 offset:37888
    ds_read_b64_tr_b16 v[50:51], v24 offset:38016
    ds_read_b128 v[52:55], v25 offset:9280
    s_waitcnt lgkmcnt(12)
    v_mfma_f32_16x16x32_bf16 v[32:35], v[64:67], v[68:71], v[32:35]
    s_waitcnt lgkmcnt(9)
    v_mfma_f32_16x16x32_bf16 v[32:35], v[72:75], v[76:79], v[32:35]
    s_waitcnt lgkmcnt(6)
    v_mfma_f32_16x16x32_bf16 v[32:35], v[80:83], v[84:87], v[32:35]
    s_waitcnt lgkmcnt(3)
    v_mfma_f32_16x16x32_bf16 v[32:35], v[40:43], v[44:47], v[32:35]
    s_waitcnt lgkmcnt(0)
    v_mfma_f32_16x16x32_bf16 v[32:35], v[48:51], v[52:55], v[32:35]
    v_mov_b32 v29, 8260
    ds_write_b32 v29, v18
    s_lshl_b32 s33, s28, 13
    s_add_u32 s33, s33, 1048576
    s_lshl_b32 s34, s25, 9
    s_add_u32 s34, s34, s33
    s_lshl_b32 s35, s27, 6
    s_add_u32 s33, s33, s35
    v_lshrrev_b32 v28, 2, v0
    v_and_b32 v29, 48, v22
    v_lshl_add_u32 v28, v28, 9, v29
    v_cvt_pk_bf16_f32 v32, v32, v32
    v_and_b32 v32, 0xffff0000, v32
    v_cvt_pk_bf16_f32 v33, v33, v33
    v_and_b32 v33, 0xffff0000, v33
    v_cvt_pk_bf16_f32 v34, v34, v34
    v_and_b32 v34, 0xffff0000, v34
    v_cvt_pk_bf16_f32 v35, v35, v35
    v_and_b32 v35, 0xffff0000, v35
    v_or_b32 v32, s65, v32
    ds_bpermute_b32 v32, v26, v32
    v_or_b32 v33, s65, v33
    ds_bpermute_b32 v33, v26, v33
    v_or_b32 v34, s65, v34
    ds_bpermute_b32 v34, v26, v34
    v_or_b32 v35, s65, v35
    ds_bpermute_b32 v35, v26, v35
    v_lshlrev_b32 v27, 4, v0
    s_mov_b32 exec_hi, 0
    s_waitcnt lgkmcnt(0)
    buffer_store_dwordx4 v[32:35], v27, s[20:23], s34 offen sc1
    s_mov_b32 exec_hi, -1
    s_waitcnt vmcnt(0)
    s_mov_b32 s66, 0xffffffff
    s_mov_b32 s67, 0xffffffff
    s_mov_b32 s76, 0x8000
    s_mov_b64 exec, s[66:67]
    buffer_load_dwordx4 v[40:43], v28, s[20:23], s33 offen offset:0 sc1 nt
    s_branch L_g4c
L_g4:
    s_sleep 4
    s_mov_b64 exec, s[66:67]
    buffer_load_dwordx4 v[40:43], v28, s[20:23], s33 offen offset:0 sc1 nt
L_g4c:
    s_waitcnt vmcnt(0)
    s_mov_b64 exec, s[66:67]
    v_xor_b32 v40, s65, v40
    v_xor_b32 v41, s65, v41
    v_xor_b32 v42, s65, v42
    v_xor_b32 v43, s65, v43
    v_or3_b32 v29, v40, v41, v42
    v_or_b32 v29, v29, v43
    v_lshlrev_b32 v29, 22, v29
    v_cmp_ne_u32 s[66:67], 0, v29
    s_mov_b64 s[74:75], s[66:67]
    s_cmp_eq_u64 s[74:75], 0
    s_cbranch_scc1 L_g4d
    s_sub_u32 s76, s76, 1
    s_cbranch_scc0 L_g4
L_g4d:
    s_mov_b64 exec, -1
    v_lshlrev_b32 v27, 3, v0
    v_cvt_pk_bf16_f32 v40, v40, v41
    v_cvt_pk_bf16_f32 v41, v42, v43
    ds_write_b64 v27, v[40:41] offset:0
    s_waitcnt lgkmcnt(0)
L_b1:
    s_barrier
    s_setprio 0
    s_mov_b32 s12, s48
    s_mov_b32 s13, s49
    s_mov_b32 s14, 3670016
    s_mov_b32 s15, 0x20000
    s_lshl_b32 s77, s28, 2
    s_add_u32 s77, s77, s26
    s_mul_i32 s77, s77, 57344
    v_mul_u32_u24 v1, 7168, v21
    v_add_u32 v1, v1, v22
    s_mul_i32 s24, s26, 14336
    s_add_u32 s24, s24, 81920
    buffer_load_dwordx4 v[32:35], v1, s[12:15], s77 offen offset:0 nt
    s_waitcnt vmcnt(1)
    buffer_load_dwordx4 v[36:39], v1, s[12:15], s77 offen offset:128 nt
    s_waitcnt vmcnt(1)
    buffer_load_dwordx4 v[40:43], v1, s[12:15], s77 offen offset:256 nt
    s_waitcnt vmcnt(1)
    buffer_load_dwordx4 v[44:47], v1, s[12:15], s77 offen offset:384 nt
    s_waitcnt vmcnt(1)
    buffer_load_dwordx4 v[48:51], v1, s[12:15], s77 offen offset:512 nt
    s_waitcnt vmcnt(1)
    buffer_load_dwordx4 v[52:55], v1, s[12:15], s77 offen offset:640 nt
    s_waitcnt vmcnt(1)
    buffer_load_dwordx4 v[56:59], v1, s[12:15], s77 offen offset:768 nt
    s_waitcnt vmcnt(1)
    s_add_u32 s77, s77, 896
    buffer_load_dwordx4 v[60:63], v1, s[12:15], s77 offen offset:0 nt
    s_waitcnt vmcnt(1)
    buffer_load_dwordx4 v[64:67], v1, s[12:15], s77 offen offset:128 nt
    s_waitcnt vmcnt(1)
    buffer_load_dwordx4 v[68:71], v1, s[12:15], s77 offen offset:256 nt
    s_waitcnt vmcnt(1)
    buffer_load_dwordx4 v[72:75], v1, s[12:15], s77 offen offset:384 nt
    s_waitcnt vmcnt(1)
    buffer_load_dwordx4 v[76:79], v1, s[12:15], s77 offen offset:512 nt
    s_waitcnt vmcnt(1)
    buffer_load_dwordx4 v[80:83], v1, s[12:15], s77 offen offset:640 nt
    s_waitcnt vmcnt(1)
    buffer_load_dwordx4 v[84:87], v1, s[12:15], s77 offen offset:768 nt
    s_waitcnt vmcnt(1)
    s_add_u32 s77, s77, 896
    buffer_load_dwordx4 v[88:91], v1, s[12:15], s77 offen offset:0 nt
    s_waitcnt vmcnt(1)
    buffer_load_dwordx4 v[92:95], v1, s[12:15], s77 offen offset:128 nt
    s_waitcnt vmcnt(1)
    buffer_load_dwordx4 v[96:99], v1, s[12:15], s77 offen offset:256 nt
    s_waitcnt vmcnt(1)
    buffer_load_dwordx4 v[100:103], v1, s[12:15], s77 offen offset:384 nt
    s_waitcnt vmcnt(1)
    buffer_load_dwordx4 v[104:107], v1, s[12:15], s77 offen offset:512 nt
    s_waitcnt vmcnt(1)
    buffer_load_dwordx4 v[108:111], v1, s[12:15], s77 offen offset:640 nt
    s_waitcnt vmcnt(1)
    buffer_load_dwordx4 v[112:115], v1, s[12:15], s77 offen offset:768 nt
    s_waitcnt vmcnt(1)
    s_add_u32 s77, s77, 896
    buffer_load_dwordx4 v[116:119], v1, s[12:15], s77 offen offset:0 nt
    s_waitcnt vmcnt(1)
    buffer_load_dwordx4 v[120:123], v1, s[12:15], s77 offen offset:128 nt
    s_waitcnt vmcnt(1)
    buffer_load_dwordx4 v[124:127], v1, s[12:15], s77 offen offset:256 nt
    s_waitcnt vmcnt(1)
    buffer_load_dwordx4 v[128:131], v1, s[12:15], s77 offen offset:384 nt
    s_waitcnt vmcnt(1)
    buffer_load_dwordx4 v[132:135], v1, s[12:15], s77 offen offset:512 nt
    s_waitcnt vmcnt(1)
    buffer_load_dwordx4 v[136:139], v1, s[12:15], s77 offen offset:640 nt
    s_waitcnt vmcnt(1)
    buffer_load_dwordx4 v[140:143], v1, s[12:15], s77 offen offset:768 nt
    s_waitcnt vmcnt(1)
    s_add_u32 s77, s77, 896
    buffer_load_dwordx4 v[144:147], v1, s[12:15], s77 offen offset:0 nt
    s_waitcnt vmcnt(1)
    buffer_load_dwordx4 v[148:151], v1, s[12:15], s77 offen offset:128 nt
    s_waitcnt vmcnt(1)
    buffer_load_dwordx4 v[152:155], v1, s[12:15], s77 offen offset:256 nt
    s_waitcnt vmcnt(1)
    buffer_load_dwordx4 v[156:159], v1, s[12:15], s77 offen offset:384 nt
    s_waitcnt vmcnt(1)
    buffer_load_dwordx4 v[160:163], v1, s[12:15], s77 offen offset:512 nt
    s_waitcnt vmcnt(1)
    buffer_load_dwordx4 v[164:167], v1, s[12:15], s77 offen offset:640 nt
    s_waitcnt vmcnt(1)
    buffer_load_dwordx4 v[168:171], v1, s[12:15], s77 offen offset:768 nt
    s_waitcnt vmcnt(1)
    s_add_u32 s77, s77, 896
    buffer_load_dwordx4 v[172:175], v1, s[12:15], s77 offen offset:0 nt
    s_waitcnt vmcnt(1)
    buffer_load_dwordx4 v[176:179], v1, s[12:15], s77 offen offset:128 nt
    s_waitcnt vmcnt(1)
    buffer_load_dwordx4 v[180:183], v1, s[12:15], s77 offen offset:256 nt
    s_waitcnt vmcnt(1)
    buffer_load_dwordx4 v[184:187], v1, s[12:15], s77 offen offset:384 nt
    s_waitcnt vmcnt(1)
    buffer_load_dwordx4 v[188:191], v1, s[12:15], s77 offen offset:512 nt
    s_waitcnt vmcnt(1)
    buffer_load_dwordx4 v[192:195], v1, s[12:15], s77 offen offset:640 nt
    s_waitcnt vmcnt(1)
    buffer_load_dwordx4 v[196:199], v1, s[12:15], s77 offen offset:768 nt
    s_waitcnt vmcnt(1)
    s_add_u32 s77, s77, 896
    s_add_u32 m0, s24, 0
    s_nop 0
    buffer_load_dwordx4 v1, s[12:15], s77 offen offset:0 nt lds
    s_waitcnt vmcnt(1)
    s_add_u32 m0, s24, 896
    s_nop 0
    buffer_load_dwordx4 v1, s[12:15], s77 offen offset:128 nt lds
    s_waitcnt vmcnt(1)
    s_add_u32 m0, s24, 1792
    s_nop 0
    buffer_load_dwordx4 v1, s[12:15], s77 offen offset:256 nt lds
    s_waitcnt vmcnt(1)
    s_add_u32 m0, s24, 2688
    s_nop 0
    buffer_load_dwordx4 v1, s[12:15], s77 offen offset:384 nt lds
    s_waitcnt vmcnt(1)
    s_add_u32 m0, s24, 3584
    s_nop 0
    buffer_load_dwordx4 v1, s[12:15], s77 offen offset:512 nt lds
    s_waitcnt vmcnt(1)
    s_add_u32 m0, s24, 4480
    s_nop 0
    buffer_load_dwordx4 v1, s[12:15], s77 offen offset:640 nt lds
    s_waitcnt vmcnt(1)
    s_add_u32 m0, s24, 5376
    s_nop 0
    buffer_load_dwordx4 v1, s[12:15], s77 offen offset:768 nt lds
    s_waitcnt vmcnt(1)
    s_add_u32 s77, s77, 896
    s_add_u32 m0, s24, 7168
    s_nop 0
    buffer_load_dwordx4 v1, s[12:15], s77 offen offset:0 nt lds
    s_waitcnt vmcnt(1)
    s_add_u32 m0, s24, 8064
    s_nop 0
    buffer_load_dwordx4 v1, s[12:15], s77 offen offset:128 nt lds
    s_waitcnt vmcnt(1)
    s_add_u32 m0, s24, 8960
    s_nop 0
    buffer_load_dwordx4 v1, s[12:15], s77 offen offset:256 nt lds
    s_waitcnt vmcnt(1)
    s_add_u32 m0, s24, 9856
    s_nop 0
    buffer_load_dwordx4 v1, s[12:15], s77 offen offset:384 nt lds
    s_waitcnt vmcnt(1)
    s_add_u32 m0, s24, 10752
    s_nop 0
    buffer_load_dwordx4 v1, s[12:15], s77 offen offset:512 nt lds
    s_waitcnt vmcnt(1)
    s_add_u32 m0, s24, 11648
    s_nop 0
    buffer_load_dwordx4 v1, s[12:15], s77 offen offset:640 nt lds
    s_waitcnt vmcnt(1)
    s_add_u32 m0, s24, 12544
    s_nop 0
    buffer_load_dwordx4 v1, s[12:15], s77 offen offset:768 nt lds
    s_waitcnt vmcnt(1)
    s_add_u32 s77, s77, 896
    s_cmp_ge_u32 s2, 84
    s_cbranch_scc1 L_wo1
    s_mov_b32 s14, 1605632
    s_mov_b32 s79, 3584
    s_lshl_b32 s33, s2, 7
    s_mov_b32 s12, s52
    s_mov_b32 s13, s53
    s_cmp_lt_u32 s2, 28
    s_cbranch_scc1 L_ft
    s_sub_u32 s33, s33, 3584
    s_mov_b32 s12, s54
    s_mov_b32 s13, s55
    s_cmp_lt_u32 s2, 56
    s_cbranch_scc1 L_ft
    s_mov_b32 s79, 896
    s_mov_b32 s12, s56
    s_mov_b32 s13, s57
    s_sub_u32 s30, s2, 56
    s_mul_i32 s30, s30, 37
    s_lshr_b32 s30, s30, 8
    s_mul_i32 s34, s30, 400512
    s_add_u32 s33, s33, s34
    s_sub_u32 s33, s33, 3584
L_ft:
    v_mad_u32_u24 v1, v21, s79, v22
    s_lshl_b32 s79, s79, 3
    s_mul_i32 s34, s79, s26
    s_add_u32 s33, s33, s34
    s_lshl_b32 s79, s79, 2
    s_lshl_b32 s34, s26, 10
    s_add_u32 m0, s34, 24576
    v_lshrrev_b32 v27, 4, v0
    v_bfe_u32 v28, v0, 2, 2
    v_lshl_add_u32 v27, v27, 3, v28
    v_and_b32 v28, 3, v0
    v_lshlrev_b32 v28, 3, v28
    v_lshl_add_u32 v27, v27, 7, v28
    s_lshl_b32 s34, s26, 5
    s_add_u32 s34, s34, 24576
    v_add_u32 v24, s34, v27
    buffer_load_dwordx4 v1, s[12:15], s33 offen nt lds
    s_add_u32 m0, m0, 4096
    s_add_u32 s33, s33, s79
    s_waitcnt vmcnt(1)
    buffer_load_dwordx4 v1, s[12:15], s33 offen nt lds
    s_add_u32 m0, m0, 4096
    s_add_u32 s33, s33, s79
    s_waitcnt vmcnt(1)
    buffer_load_dwordx4 v1, s[12:15], s33 offen nt lds
    s_add_u32 m0, m0, 4096
    s_add_u32 s33, s33, s79
    s_waitcnt vmcnt(1)
    buffer_load_dwordx4 v1, s[12:15], s33 offen nt lds
    s_add_u32 m0, m0, 4096
    s_add_u32 s33, s33, s79
    s_waitcnt vmcnt(1)
    buffer_load_dwordx4 v1, s[12:15], s33 offen nt lds
    s_add_u32 m0, m0, 4096
    s_add_u32 s33, s33, s79
    s_waitcnt vmcnt(1)
    buffer_load_dwordx4 v1, s[12:15], s33 offen nt lds
    s_add_u32 m0, m0, 4096
    s_add_u32 s33, s33, s79
    s_waitcnt vmcnt(1)
    buffer_load_dwordx4 v1, s[12:15], s33 offen nt lds
    s_add_u32 m0, m0, 4096
    s_add_u32 s33, s33, s79
    s_waitcnt vmcnt(1)
    buffer_load_dwordx4 v1, s[12:15], s33 offen nt lds
    s_add_u32 m0, m0, 4096
    s_add_u32 s33, s33, s79
    s_waitcnt vmcnt(1)
    buffer_load_dwordx4 v1, s[12:15], s33 offen nt lds
    s_add_u32 m0, m0, 4096
    s_add_u32 s33, s33, s79
    s_waitcnt vmcnt(1)
    buffer_load_dwordx4 v1, s[12:15], s33 offen nt lds
    s_add_u32 m0, m0, 4096
    s_add_u32 s33, s33, s79
    s_waitcnt vmcnt(1)
    buffer_load_dwordx4 v1, s[12:15], s33 offen nt lds
    s_add_u32 m0, m0, 4096
    s_add_u32 s33, s33, s79
    s_waitcnt vmcnt(1)
    buffer_load_dwordx4 v1, s[12:15], s33 offen nt lds
    s_add_u32 m0, m0, 4096
    s_add_u32 s33, s33, s79
    s_waitcnt vmcnt(1)
    buffer_load_dwordx4 v1, s[12:15], s33 offen nt lds
    s_add_u32 m0, m0, 4096
    s_add_u32 s33, s33, s79
    s_waitcnt vmcnt(1)
    buffer_load_dwordx4 v1, s[12:15], s33 offen nt lds
    s_cmp_lt_u32 s2, 56
    s_cbranch_scc1 L_h3
    v_mov_b32 v27, 0
    s_mov_b32 s76, 0x10000
L_p5:
    ds_read_b32 v28, v27 offset:1024
    s_sub_u32 s76, s76, 1
    s_cbranch_scc1 L_p5d
    s_waitcnt lgkmcnt(0)
    v_readfirstlane_b32 s34, v28
    s_cmp_le_u32 s34, 5
    s_cbranch_scc1 L_p5d
    s_sleep 4
    s_branch L_p5
L_p5d:
    s_mul_i32 s33, s30, 14336
    s_lshl_b32 s34, s26, 12
    s_add_u32 s33, s33, s34
    s_add_u32 s33, s33, 1179648
    v_lshlrev_b32 v28, 4, v0
    v_bfe_u32 v29, v0, 2, 3
    v_mul_u32_u24 v29, 912, v29
    v_and_b32 v30, 3, v0
    v_lshl_add_u32 v29, v30, 3, v29
    v_and_b32 v30, 32, v0
    s_lshl_b32 s34, s26, 8
    v_add3_u32 v29, v29, v30, s34
    s_mov_b32 s66, 0xffffffff
    s_mov_b32 s67, 0xffffffff
    s_mov_b32 s68, 0xffffffff
    s_mov_b32 s69, 0xffffffff
    s_mov_b32 s70, 0xffffffff
    s_mov_b32 s71, 0xffffffff
    s_mov_b32 s72, 0xffffffff
    s_mov_b32 s73, 0xffffffff
    s_mov_b32 s76, 0x8000
    s_cmp_eq_u32 s26, 3
    s_cselect_b64 s[70:71], 0, -1
    s_cselect_b64 s[72:73], 0, -1
    s_mov_b64 exec, s[66:67]
    buffer_load_dwordx4 v[200:203], v28, s[20:23], s33 offen offset:0 sc1 nt
    s_mov_b64 exec, s[68:69]
    buffer_load_dwordx4 v[204:207], v28, s[20:23], s33 offen offset:1024 sc1 nt
    s_mov_b64 exec, s[70:71]
    buffer_load_dwordx4 v[208:211], v28, s[20:23], s33 offen offset:2048 sc1 nt
    s_mov_b64 exec, s[72:73]
    buffer_load_dwordx4 v[212:215], v28, s[20:23], s33 offen offset:3072 sc1 nt
    s_branch L_g6c
L_g6:
    s_sleep 32
    s_mov_b64 exec, s[66:67]
    buffer_load_dwordx4 v[200:203], v28, s[20:23], s33 offen offset:0 sc1 nt
    s_mov_b64 exec, s[68:69]
    buffer_load_dwordx4 v[204:207], v28, s[20:23], s33 offen offset:1024 sc1 nt
    s_mov_b64 exec, s[70:71]
    buffer_load_dwordx4 v[208:211], v28, s[20:23], s33 offen offset:2048 sc1 nt
    s_mov_b64 exec, s[72:73]
    buffer_load_dwordx4 v[212:215], v28, s[20:23], s33 offen offset:3072 sc1 nt
L_g6c:
    s_waitcnt vmcnt(0)
    s_mov_b64 exec, s[66:67]
    v_xor_b32 v200, s65, v200
    v_xor_b32 v201, s65, v201
    v_xor_b32 v202, s65, v202
    v_xor_b32 v203, s65, v203
    v_or3_b32 v30, v200, v201, v202
    v_or_b32 v30, v30, v203
    v_lshlrev_b32 v30, 22, v30
    v_cmp_ne_u32 s[66:67], 0, v30
    s_mov_b64 exec, s[68:69]
    v_xor_b32 v204, s65, v204
    v_xor_b32 v205, s65, v205
    v_xor_b32 v206, s65, v206
    v_xor_b32 v207, s65, v207
    v_or3_b32 v30, v204, v205, v206
    v_or_b32 v30, v30, v207
    v_lshlrev_b32 v30, 22, v30
    v_cmp_ne_u32 s[68:69], 0, v30
    s_mov_b64 exec, s[70:71]
    v_xor_b32 v208, s65, v208
    v_xor_b32 v209, s65, v209
    v_xor_b32 v210, s65, v210
    v_xor_b32 v211, s65, v211
    v_or3_b32 v30, v208, v209, v210
    v_or_b32 v30, v30, v211
    v_lshlrev_b32 v30, 22, v30
    v_cmp_ne_u32 s[70:71], 0, v30
    s_mov_b64 exec, s[72:73]
    v_xor_b32 v212, s65, v212
    v_xor_b32 v213, s65, v213
    v_xor_b32 v214, s65, v214
    v_xor_b32 v215, s65, v215
    v_or3_b32 v30, v212, v213, v214
    v_or_b32 v30, v30, v215
    v_lshlrev_b32 v30, 22, v30
    v_cmp_ne_u32 s[72:73], 0, v30
    s_mov_b64 s[74:75], s[66:67]
    s_or_b64 s[74:75], s[74:75], s[68:69]
    s_or_b64 s[74:75], s[74:75], s[70:71]
    s_or_b64 s[74:75], s[74:75], s[72:73]
    s_cmp_eq_u64 s[74:75], 0
    s_cbranch_scc1 L_g6d
    s_sub_u32 s76, s76, 1
    s_cbranch_scc0 L_g6
L_g6d:
    s_mov_b64 exec, -1
    s_add_u32 s33, s33, 57344
    s_mov_b32 s66, 0xffffffff
    s_mov_b32 s67, 0xffffffff
    s_mov_b32 s68, 0xffffffff
    s_mov_b32 s69, 0xffffffff
    s_mov_b32 s70, 0xffffffff
    s_mov_b32 s71, 0xffffffff
    s_mov_b32 s72, 0xffffffff
    s_mov_b32 s73, 0xffffffff
    s_mov_b32 s76, 0x8000
    s_cmp_eq_u32 s26, 3
    s_cselect_b64 s[70:71], 0, -1
    s_cselect_b64 s[72:73], 0, -1
    s_mov_b64 exec, s[66:67]
    buffer_load_dwordx4 v[216:219], v28, s[20:23], s33 offen offset:0 sc1 nt
    s_mov_b64 exec, s[68:69]
    buffer_load_dwordx4 v[220:223], v28, s[20:23], s33 offen offset:1024 sc1 nt
    s_mov_b64 exec, s[70:71]
    buffer_load_dwordx4 v[224:227], v28, s[20:23], s33 offen offset:2048 sc1 nt
    s_mov_b64 exec, s[72:73]
    buffer_load_dwordx4 v[228:231], v28, s[20:23], s33 offen offset:3072 sc1 nt
    s_branch L_g7c
L_g7:
    s_sleep 32
    s_mov_b64 exec, s[66:67]
    buffer_load_dwordx4 v[216:219], v28, s[20:23], s33 offen offset:0 sc1 nt
    s_mov_b64 exec, s[68:69]
    buffer_load_dwordx4 v[220:223], v28, s[20:23], s33 offen offset:1024 sc1 nt
    s_mov_b64 exec, s[70:71]
    buffer_load_dwordx4 v[224:227], v28, s[20:23], s33 offen offset:2048 sc1 nt
    s_mov_b64 exec, s[72:73]
    buffer_load_dwordx4 v[228:231], v28, s[20:23], s33 offen offset:3072 sc1 nt
L_g7c:
    s_waitcnt vmcnt(0)
    s_mov_b64 exec, s[66:67]
    v_xor_b32 v216, s65, v216
    v_xor_b32 v217, s65, v217
    v_xor_b32 v218, s65, v218
    v_xor_b32 v219, s65, v219
    v_or3_b32 v30, v216, v217, v218
    v_or_b32 v30, v30, v219
    v_lshlrev_b32 v30, 22, v30
    v_cmp_ne_u32 s[66:67], 0, v30
    s_mov_b64 exec, s[68:69]
    v_xor_b32 v220, s65, v220
    v_xor_b32 v221, s65, v221
    v_xor_b32 v222, s65, v222
    v_xor_b32 v223, s65, v223
    v_or3_b32 v30, v220, v221, v222
    v_or_b32 v30, v30, v223
    v_lshlrev_b32 v30, 22, v30
    v_cmp_ne_u32 s[68:69], 0, v30
    s_mov_b64 exec, s[70:71]
    v_xor_b32 v224, s65, v224
    v_xor_b32 v225, s65, v225
    v_xor_b32 v226, s65, v226
    v_xor_b32 v227, s65, v227
    v_or3_b32 v30, v224, v225, v226
    v_or_b32 v30, v30, v227
    v_lshlrev_b32 v30, 22, v30
    v_cmp_ne_u32 s[70:71], 0, v30
    s_mov_b64 exec, s[72:73]
    v_xor_b32 v228, s65, v228
    v_xor_b32 v229, s65, v229
    v_xor_b32 v230, s65, v230
    v_xor_b32 v231, s65, v231
    v_or3_b32 v30, v228, v229, v230
    v_or_b32 v30, v30, v231
    v_lshlrev_b32 v30, 22, v30
    v_cmp_ne_u32 s[72:73], 0, v30
    s_mov_b64 s[74:75], s[66:67]
    s_or_b64 s[74:75], s[74:75], s[68:69]
    s_or_b64 s[74:75], s[74:75], s[70:71]
    s_or_b64 s[74:75], s[74:75], s[72:73]
    s_cmp_eq_u64 s[74:75], 0
    s_cbranch_scc1 L_g7d
    s_sub_u32 s76, s76, 1
    s_cbranch_scc0 L_g7
L_g7d:
    s_mov_b64 exec, -1
    v_mul_f32 v27, v200, v200
    v_mul_f32 v27, 0x3d372713, v27
    v_fma_f32 v27, v27, v200, v200
    v_mul_f32 v27, 0xc0135761, v27
    v_exp_f32 v27, v27
    s_nop 0
    v_add_f32 v27, 1.0, v27
    v_rcp_f32 v27, v27
    s_nop 0
    v_mul_f32 v200, v200, v27
    v_cvt_pk_bf16_f32 v200, v200, v200
    v_and_b32 v200, 0xffff0000, v200
    v_mul_f32 v200, v200, v216
    v_mul_f32 v27, v201, v201
    v_mul_f32 v27, 0x3d372713, v27
    v_fma_f32 v27, v27, v201, v201
    v_mul_f32 v27, 0xc0135761, v27
    v_exp_f32 v27, v27
    s_nop 0
    v_add_f32 v27, 1.0, v27
    v_rcp_f32 v27, v27
    s_nop 0
    v_mul_f32 v201, v201, v27
    v_cvt_pk_bf16_f32 v201, v201, v201
    v_and_b32 v201, 0xffff0000, v201
    v_mul_f32 v201, v201, v217
    v_mul_f32 v27, v202, v202
    v_mul_f32 v27, 0x3d372713, v27
    v_fma_f32 v27, v27, v202, v202
    v_mul_f32 v27, 0xc0135761, v27
    v_exp_f32 v27, v27
    s_nop 0
    v_add_f32 v27, 1.0, v27
    v_rcp_f32 v27, v27
    s_nop 0
    v_mul_f32 v202, v202, v27
    v_cvt_pk_bf16_f32 v202, v202, v202
    v_and_b32 v202, 0xffff0000, v202
    v_mul_f32 v202, v202, v218
    v_mul_f32 v27, v203, v203
    v_mul_f32 v27, 0x3d372713, v27
    v_fma_f32 v27, v27, v203, v203
    v_mul_f32 v27, 0xc0135761, v27
    v_exp_f32 v27, v27
    s_nop 0
    v_add_f32 v27, 1.0, v27
    v_rcp_f32 v27, v27
    s_nop 0
    v_mul_f32 v203, v203, v27
    v_cvt_pk_bf16_f32 v203, v203, v203
    v_and_b32 v203, 0xffff0000, v203
    v_mul_f32 v203, v203, v219
    v_cvt_pk_bf16_f32 v200, v200, v201
    v_cvt_pk_bf16_f32 v201, v202, v203
    ds_write_b64 v29, v[200:201] offset:8448
    v_mul_f32 v27, v204, v204
    v_mul_f32 v27, 0x3d372713, v27
    v_fma_f32 v27, v27, v204, v204
    v_mul_f32 v27, 0xc0135761, v27
    v_exp_f32 v27, v27
    s_nop 0
    v_add_f32 v27, 1.0, v27
    v_rcp_f32 v27, v27
    s_nop 0
    v_mul_f32 v204, v204, v27
    v_cvt_pk_bf16_f32 v204, v204, v204
    v_and_b32 v204, 0xffff0000, v204
    v_mul_f32 v204, v204, v220
    v_mul_f32 v27, v205, v205
    v_mul_f32 v27, 0x3d372713, v27
    v_fma_f32 v27, v27, v205, v205
    v_mul_f32 v27, 0xc0135761, v27
    v_exp_f32 v27, v27
    s_nop 0
    v_add_f32 v27, 1.0, v27
    v_rcp_f32 v27, v27
    s_nop 0
    v_mul_f32 v205, v205, v27
    v_cvt_pk_bf16_f32 v205, v205, v205
    v_and_b32 v205, 0xffff0000, v205
    v_mul_f32 v205, v205, v221
    v_mul_f32 v27, v206, v206
    v_mul_f32 v27, 0x3d372713, v27
    v_fma_f32 v27, v27, v206, v206
    v_mul_f32 v27, 0xc0135761, v27
    v_exp_f32 v27, v27
    s_nop 0
    v_add_f32 v27, 1.0, v27
    v_rcp_f32 v27, v27
    s_nop 0
    v_mul_f32 v206, v206, v27
    v_cvt_pk_bf16_f32 v206, v206, v206
    v_and_b32 v206, 0xffff0000, v206
    v_mul_f32 v206, v206, v222
    v_mul_f32 v27, v207, v207
    v_mul_f32 v27, 0x3d372713, v27
    v_fma_f32 v27, v27, v207, v207
    v_mul_f32 v27, 0xc0135761, v27
    v_exp_f32 v27, v27
    s_nop 0
    v_add_f32 v27, 1.0, v27
    v_rcp_f32 v27, v27
    s_nop 0
    v_mul_f32 v207, v207, v27
    v_cvt_pk_bf16_f32 v207, v207, v207
    v_and_b32 v207, 0xffff0000, v207
    v_mul_f32 v207, v207, v223
    v_cvt_pk_bf16_f32 v204, v204, v205
    v_cvt_pk_bf16_f32 v205, v206, v207
    ds_write_b64 v29, v[204:205] offset:8512
    s_cmp_eq_u32 s26, 3
    s_cbranch_scc1 L_h3
    v_mul_f32 v27, v208, v208
    v_mul_f32 v27, 0x3d372713, v27
    v_fma_f32 v27, v27, v208, v208
    v_mul_f32 v27, 0xc0135761, v27
    v_exp_f32 v27, v27
    s_nop 0
    v_add_f32 v27, 1.0, v27
    v_rcp_f32 v27, v27
    s_nop 0
    v_mul_f32 v208, v208, v27
    v_cvt_pk_bf16_f32 v208, v208, v208
    v_and_b32 v208, 0xffff0000, v208
    v_mul_f32 v208, v208, v224
    v_mul_f32 v27, v209, v209
    v_mul_f32 v27, 0x3d372713, v27
    v_fma_f32 v27, v27, v209, v209
    v_mul_f32 v27, 0xc0135761, v27
    v_exp_f32 v27, v27
    s_nop 0
    v_add_f32 v27, 1.0, v27
    v_rcp_f32 v27, v27
    s_nop 0
    v_mul_f32 v209, v209, v27
    v_cvt_pk_bf16_f32 v209, v209, v209
    v_and_b32 v209, 0xffff0000, v209
    v_mul_f32 v209, v209, v225
    v_mul_f32 v27, v210, v210
    v_mul_f32 v27, 0x3d372713, v27
    v_fma_f32 v27, v27, v210, v210
    v_mul_f32 v27, 0xc0135761, v27
    v_exp_f32 v27, v27
    s_nop 0
    v_add_f32 v27, 1.0, v27
    v_rcp_f32 v27, v27
    s_nop 0
    v_mul_f32 v210, v210, v27
    v_cvt_pk_bf16_f32 v210, v210, v210
    v_and_b32 v210, 0xffff0000, v210
    v_mul_f32 v210, v210, v226
    v_mul_f32 v27, v211, v211
    v_mul_f32 v27, 0x3d372713, v27
    v_fma_f32 v27, v27, v211, v211
    v_mul_f32 v27, 0xc0135761, v27
    v_exp_f32 v27, v27
    s_nop 0
    v_add_f32 v27, 1.0, v27
    v_rcp_f32 v27, v27
    s_nop 0
    v_mul_f32 v211, v211, v27
    v_cvt_pk_bf16_f32 v211, v211, v211
    v_and_b32 v211, 0xffff0000, v211
    v_mul_f32 v211, v211, v227
    v_cvt_pk_bf16_f32 v208, v208, v209
    v_cvt_pk_bf16_f32 v209, v210, v211
    ds_write_b64 v29, v[208:209] offset:8576
    v_mul_f32 v27, v212, v212
    v_mul_f32 v27, 0x3d372713, v27
    v_fma_f32 v27, v27, v212, v212
    v_mul_f32 v27, 0xc0135761, v27
    v_exp_f32 v27, v27
    s_nop 0
    v_add_f32 v27, 1.0, v27
    v_rcp_f32 v27, v27
    s_nop 0
    v_mul_f32 v212, v212, v27
    v_cvt_pk_bf16_f32 v212, v212, v212
    v_and_b32 v212, 0xffff0000, v212
    v_mul_f32 v212, v212, v228
    v_mul_f32 v27, v213, v213
    v_mul_f32 v27, 0x3d372713, v27
    v_fma_f32 v27, v27, v213, v213
    v_mul_f32 v27, 0xc0135761, v27
    v_exp_f32 v27, v27
    s_nop 0
    v_add_f32 v27, 1.0, v27
    v_rcp_f32 v27, v27
    s_nop 0
    v_mul_f32 v213, v213, v27
    v_cvt_pk_bf16_f32 v213, v213, v213
    v_and_b32 v213, 0xffff0000, v213
    v_mul_f32 v213, v213, v229
    v_mul_f32 v27, v214, v214
    v_mul_f32 v27, 0x3d372713, v27
    v_fma_f32 v27, v27, v214, v214
    v_mul_f32 v27, 0xc0135761, v27
    v_exp_f32 v27, v27
    s_nop 0
    v_add_f32 v27, 1.0, v27
    v_rcp_f32 v27, v27
    s_nop 0
    v_mul_f32 v214, v214, v27
    v_cvt_pk_bf16_f32 v214, v214, v214
    v_and_b32 v214, 0xffff0000, v214
    v_mul_f32 v214, v214, v230
    v_mul_f32 v27, v215, v215
    v_mul_f32 v27, 0x3d372713, v27
    v_fma_f32 v27, v27, v215, v215
    v_mul_f32 v27, 0xc0135761, v27
    v_exp_f32 v27, v27
    s_nop 0
    v_add_f32 v27, 1.0, v27
    v_rcp_f32 v27, v27
    s_nop 0
    v_mul_f32 v215, v215, v27
    v_cvt_pk_bf16_f32 v215, v215, v215
    v_and_b32 v215, 0xffff0000, v215
    v_mul_f32 v215, v215, v231
    v_cvt_pk_bf16_f32 v212, v212, v213
    v_cvt_pk_bf16_f32 v213, v214, v215
    ds_write_b64 v29, v[212:213] offset:8640
L_h3:
    s_waitcnt vmcnt(0) lgkmcnt(0)
    s_mov_b64 exec, 1
    v_mov_b32 v27, 8256
    v_mov_b32 v28, 1
    ds_add_u32 v27, v28
    s_mov_b32 s76, 0x100000
L_s8:
    ds_read_b32 v28, v27
    s_sub_u32 s76, s76, 1
    s_cbranch_scc1 L_s8d
    s_waitcnt lgkmcnt(0)
    v_readfirstlane_b32 s34, v28
    s_cmp_lt_u32 s34, 8
    s_cbranch_scc1 L_s8
L_s8d:
    s_mov_b64 exec, -1
    ds_read_b64_tr_b16 v[208:209], v24 offset:0
    ds_read_b64_tr_b16 v[210:211], v24 offset:512
    ds_read_b128 v[212:215], v25 offset:8448
    ds_read_b64_tr_b16 v[216:217], v24 offset:4096
    ds_read_b64_tr_b16 v[218:219], v24 offset:4608
    ds_read_b128 v[220:223], v25 offset:8512
    ds_read_b64_tr_b16 v[224:225], v24 offset:8192
    ds_read_b64_tr_b16 v[226:227], v24 offset:8704
    ds_read_b128 v[228:231], v25 offset:8576
    ds_read_b64_tr_b16 v[232:233], v24 offset:12288
    ds_read_b64_tr_b16 v[234:235], v24 offset:12800
    ds_read_b128 v[236:239], v25 offset:8640
    ds_read_b64_tr_b16 v[240:241], v24 offset:16384
    ds_read_b64_tr_b16 v[242:243], v24 offset:16896
    ds_read_b128 v[244:247], v25 offset:8704
    s_waitcnt lgkmcnt(12)
    v_mfma_f32_16x16x32_bf16 v[200:203], v[208:211], v[212:215], 0
    ds_read_b64_tr_b16 v[248:249], v24 offset:20480
    ds_read_b64_tr_b16 v[250:251], v24 offset:20992
    ds_read_b128 v[252:255], v25 offset:8768
    s_waitcnt lgkmcnt(12)
    v_mfma_f32_16x16x32_bf16 v[200:203], v[216:219], v[220:223], v[200:203]
    ds_read_b64_tr_b16 v[208:209], v24 offset:24576
    ds_read_b64_tr_b16 v[210:211], v24 offset:25088
    ds_read_b128 v[212:215], v25 offset:8832
    s_waitcnt lgkmcnt(12)
    v_mfma_f32_16x16x32_bf16 v[200:203], v[224:227], v[228:231], v[200:203]
    ds_read_b64_tr_b16 v[216:217], v24 offset:28672
    ds_read_b64_tr_b16 v[218:219], v24 offset:29184
    ds_read_b128 v[220:223], v25 offset:8896
    s_waitcnt lgkmcnt(12)
    v_mfma_f32_16x16x32_bf16 v[200:203], v[232:235], v[236:239], v[200:203]
    ds_read_b64_tr_b16 v[224:225], v24 offset:32768
    ds_read_b64_tr_b16 v[226:227], v24 offset:33280
    ds_read_b128 v[228:231], v25 offset:8960
    s_waitcnt lgkmcnt(12)
    v_mfma_f32_16x16x32_bf16 v[200:203], v[240:243], v[244:247], v[200:203]
    ds_read_b64_tr_b16 v[232:233], v24 offset:36864
    ds_read_b64_tr_b16 v[234:235], v24 offset:37376
    ds_read_b128 v[236:239], v25 offset:9024
    s_waitcnt lgkmcnt(12)
    v_mfma_f32_16x16x32_bf16 v[200:203], v[248:251], v[252:255], v[200:203]
    ds_read_b64_tr_b16 v[240:241], v24 offset:40960
    ds_read_b64_tr_b16 v[242:243], v24 offset:41472
    ds_read_b128 v[244:247], v25 offset:9088
    s_waitcnt lgkmcnt(12)
    v_mfma_f32_16x16x32_bf16 v[200:203], v[208:211], v[212:215], v[200:203]
    ds_read_b64_tr_b16 v[248:249], v24 offset:45056
    ds_read_b64_tr_b16 v[250:251], v24 offset:45568
    ds_read_b128 v[252:255], v25 offset:9152
    s_waitcnt lgkmcnt(12)
    v_mfma_f32_16x16x32_bf16 v[200:203], v[216:219], v[220:223], v[200:203]
    ds_read_b64_tr_b16 v[208:209], v24 offset:49152
    ds_read_b64_tr_b16 v[210:211], v24 offset:49664
    ds_read_b128 v[212:215], v25 offset:9216
    s_waitcnt lgkmcnt(12)
    v_mfma_f32_16x16x32_bf16 v[200:203], v[224:227], v[228:231], v[200:203]
    ds_read_b64_tr_b16 v[216:217], v24 offset:53248
    ds_read_b64_tr_b16 v[218:219], v24 offset:53760
    ds_read_b128 v[220:223], v25 offset:9280
    s_waitcnt lgkmcnt(12)
    v_mfma_f32_16x16x32_bf16 v[200:203], v[232:235], v[236:239], v[200:203]
    s_waitcnt lgkmcnt(9)
    v_mfma_f32_16x16x32_bf16 v[200:203], v[240:243], v[244:247], v[200:203]
    s_waitcnt lgkmcnt(6)
    v_mfma_f32_16x16x32_bf16 v[200:203], v[248:251], v[252:255], v[200:203]
    s_waitcnt lgkmcnt(3)
    v_mfma_f32_16x16x32_bf16 v[200:203], v[208:211], v[212:215], v[200:203]
    s_waitcnt lgkmcnt(0)
    v_mfma_f32_16x16x32_bf16 v[200:203], v[216:219], v[220:223], v[200:203]
    s_lshl_b32 s33, s2, 2
    s_add_u32 s33, s33, s26
    s_lshl_b32 s33, s33, 9
    s_add_u32 s33, s33, 1179648
    s_nop 4
    s_cmp_ge_u32 s2, 56
    s_cbranch_scc1 L_fp
    v_cvt_pk_bf16_f32 v200, v200, v200
    v_and_b32 v200, 0xffff0000, v200
    v_cvt_pk_bf16_f32 v201, v201, v201
    v_and_b32 v201, 0xffff0000, v201
    v_cvt_pk_bf16_f32 v202, v202, v202
    v_and_b32 v202, 0xffff0000, v202
    v_cvt_pk_bf16_f32 v203, v203, v203
    v_and_b32 v203, 0xffff0000, v203
L_fp:
    v_add_u32 v200, 0x200, v200
    v_and_b32 v200, 0xfffffc00, v200
    v_or_b32 v200, s65, v200
    ds_bpermute_b32 v200, v26, v200
    v_add_u32 v201, 0x200, v201
    v_and_b32 v201, 0xfffffc00, v201
    v_or_b32 v201, s65, v201
    ds_bpermute_b32 v201, v26, v201
    v_add_u32 v202, 0x200, v202
    v_and_b32 v202, 0xfffffc00, v202
    v_or_b32 v202, s65, v202
    ds_bpermute_b32 v202, v26, v202
    v_add_u32 v203, 0x200, v203
    v_and_b32 v203, 0xfffffc00, v203
    v_or_b32 v203, s65, v203
    ds_bpermute_b32 v203, v26, v203
    v_lshlrev_b32 v27, 4, v0
    s_mov_b32 exec_hi, 0
    s_waitcnt lgkmcnt(0)
    buffer_store_dwordx4 v[200:203], v27, s[20:23], s33 offen sc1
    s_mov_b32 exec_hi, -1
L_wo1:
    s_cmp_lg_u32 s26, 0
    s_cbranch_scc1 L_wo2
    v_mov_b32 v27, 0
    s_mov_b32 s76, 0x10000
L_p9:
    ds_read_b32 v28, v27 offset:1024
    s_sub_u32 s76, s76, 1
    s_cbranch_scc1 L_p9d
    s_waitcnt lgkmcnt(0)
    v_readfirstlane_b32 s34, v28
    s_cmp_le_u32 s34, 2
    s_cbranch_scc1 L_p9d
    s_sleep 4
    s_branch L_p9
L_p9d:

    s_mul_i32 s34, s31, 14
    s_lshr_b32 s34, s34, 2
    v_and_b32 v27, 3, v0
    v_add_u32 v27, s34, v27
    v_lshlrev_b32 v28, 3, v27
    s_mul_i32 s34, s27, 896
    buffer_load_dwordx2 v[236:237], v28, s[16:19], s34 offen nt
    v_lshrrev_b32 v28, 2, v27
    v_and_b32 v27, 3, v27
    v_lshlrev_b32 v27, 4, v27
    v_lshl_add_u32 v27, v28, 9, v27
    v_bfe_u32 v28, v0, 2, 2
    v_mul_u32_u24 v28, 14336, v28
    v_add_u32 v27, v27, v28
    s_lshl_b32 s34, s27, 6
    s_add_u32 s34, s34, 1294336
    s_mov_b32 s66, 0xffff
    s_mov_b32 s67, 0x0
    s_mov_b32 s76, 0x8000
    s_mov_b64 exec, s[66:67]
    buffer_load_dwordx4 v[228:231], v27, s[20:23], s34 offen offset:0 sc1 nt
    s_branch L_g10c
L_g10:
    s_sleep 32
    s_mov_b64 exec, s[66:67]
    buffer_load_dwordx4 v[228:231], v27, s[20:23], s34 offen offset:0 sc1 nt
L_g10c:
    s_waitcnt vmcnt(0)
    s_mov_b64 exec, s[66:67]
    v_xor_b32 v228, s65, v228
    v_xor_b32 v229, s65, v229
    v_xor_b32 v230, s65, v230
    v_xor_b32 v231, s65, v231
    v_or3_b32 v28, v228, v229, v230
    v_or_b32 v28, v28, v231
    v_lshlrev_b32 v28, 22, v28
    v_cmp_ne_u32 s[66:67], 0, v28
    s_mov_b64 s[74:75], s[66:67]
    s_cmp_eq_u64 s[74:75], 0
    s_cbranch_scc1 L_g10d
    s_sub_u32 s76, s76, 1
    s_cbranch_scc0 L_g10
L_g10d:
    s_mov_b64 exec, -1
    v_add_f32_dpp v228, v228, v228 row_ror:4 row_mask:0xf bank_mask:0xf
    v_add_f32_dpp v229, v229, v229 row_ror:4 row_mask:0xf bank_mask:0xf
    v_add_f32_dpp v230, v230, v230 row_ror:4 row_mask:0xf bank_mask:0xf
    v_add_f32_dpp v231, v231, v231 row_ror:4 row_mask:0xf bank_mask:0xf
    v_add_f32_dpp v228, v228, v228 row_ror:8 row_mask:0xf bank_mask:0xf
    v_add_f32_dpp v229, v229, v229 row_ror:8 row_mask:0xf bank_mask:0xf
    v_add_f32_dpp v230, v230, v230 row_ror:8 row_mask:0xf bank_mask:0xf
    v_add_f32_dpp v231, v231, v231 row_ror:8 row_mask:0xf bank_mask:0xf
    v_cvt_pk_bf16_f32 v228, v228, v228
    v_and_b32 v228, 0xffff0000, v228
    v_mul_f32 v27, 0xbfb8aa3b, v228
    v_exp_f32 v27, v27
    s_nop 0
    v_add_f32 v27, 1.0, v27
    v_rcp_f32 v27, v27
    s_nop 0
    v_mul_f32 v228, v228, v27
    v_cvt_pk_bf16_f32 v228, v228, v228
    v_and_b32 v228, 0xffff0000, v228
    v_cvt_pk_bf16_f32 v229, v229, v229
    v_and_b32 v229, 0xffff0000, v229
    v_mul_f32 v27, 0xbfb8aa3b, v229
    v_exp_f32 v27, v27
    s_nop 0
    v_add_f32 v27, 1.0, v27
    v_rcp_f32 v27, v27
    s_nop 0
    v_mul_f32 v229, v229, v27
    v_cvt_pk_bf16_f32 v229, v229, v229
    v_and_b32 v229, 0xffff0000, v229
    v_cvt_pk_bf16_f32 v230, v230, v230
    v_and_b32 v230, 0xffff0000, v230
    v_mul_f32 v27, 0xbfb8aa3b, v230
    v_exp_f32 v27, v27
    s_nop 0
    v_add_f32 v27, 1.0, v27
    v_rcp_f32 v27, v27
    s_nop 0
    v_mul_f32 v230, v230, v27
    v_cvt_pk_bf16_f32 v230, v230, v230
    v_and_b32 v230, 0xffff0000, v230
    v_cvt_pk_bf16_f32 v231, v231, v231
    v_and_b32 v231, 0xffff0000, v231
    v_mul_f32 v27, 0xbfb8aa3b, v231
    v_exp_f32 v27, v27
    s_nop 0
    v_add_f32 v27, 1.0, v27
    v_rcp_f32 v27, v27
    s_nop 0
    v_mul_f32 v231, v231, v27
    v_cvt_pk_bf16_f32 v231, v231, v231
    v_and_b32 v231, 0xffff0000, v231
    v_lshlrev_b32 v232, 16, v236
    v_and_b32 v233, 0xffff0000, v236
    v_lshlrev_b32 v234, 16, v237
    v_and_b32 v235, 0xffff0000, v237
    s_mov_b64 exec, 15
    ds_write_b128 v22, v[228:231] offset:8320
    ds_write_b128 v22, v[232:235] offset:8384
    s_mov_b64 exec, -1
    s_waitcnt lgkmcnt(0)
L_wo2:
    v_lshl_add_u32 v27, v0, 4, s24
    s_waitcnt vmcnt(0)
    ds_read_b128 v[200:203], v27 offset:0
    ds_read_b128 v[204:207], v27 offset:1024
    ds_read_b128 v[208:211], v27 offset:2048
    ds_read_b128 v[212:215], v27 offset:3072
    ds_read_b128 v[216:219], v27 offset:4096
    ds_read_b128 v[220:223], v27 offset:5120
    ds_read_b128 v[224:227], v27 offset:6144
    ds_read_b128 v[228:231], v27 offset:7168
    ds_read_b128 v[232:235], v27 offset:8192
    ds_read_b128 v[236:239], v27 offset:9216
    ds_read_b128 v[240:243], v27 offset:10240
    ds_read_b128 v[244:247], v27 offset:11264
    ds_read_b128 v[248:251], v27 offset:12288
    ds_read_b128 v[252:255], v27 offset:13312
    s_waitcnt lgkmcnt(0)
    s_lshl_b32 s33, s26, 8
    v_lshl_add_u32 v27, v0, 2, s33
    v_mov_b32 v28, 0
    s_mov_b32 s64, 0x3db8aa3b
    s_lshl_b32 s33, s26, 11
    v_add_u32 v23, s33, v23
    s_mul_i32 s33, s26, 896
    s_add_u32 s33, s33, 16384
    v_lshrrev_b32 v29, 2, v0
    v_mul_u32_u24 v29, 56, v29
    v_and_b32 v30, 48, v22
    v_add3_u32 v29, v29, v30, s33
    v_lshlrev_b32 v30, 4, v0
    v_mov_b32 v31, s65
    s_lshl_b32 s33, s27, 5
    s_add_u32 s33, s33, s31
    s_lshl_b32 s33, s33, 1
    s_add_u32 s33, s33, s26
    s_lshl_b32 s33, s33, 10
    s_add_u32 s33, s33, 1572864
    s_mov_b32 s38, 0x88888888
    s_mov_b32 s39, 0x88888888
    s_mov_b32 s35, 0xfffffc00
    s_waitcnt vmcnt(0)
    s_barrier
    ds_read_b128 v[6:9], v28 offset:8192
    ds_read_b128 v[10:13], v28 offset:8208
    ds_read_b32 v14, v27 offset:4096
    ds_read_b32 v15, v27 offset:5120
    ds_read_b32 v16, v27 offset:6144
    ds_read_b32 v17, v27 offset:7168
    s_waitcnt lgkmcnt(4)
    v_max_f32 v24, v6, v8
    v_max3_f32 v24, v24, v10, v12
    v_sub_f32 v6, v6, v24
    v_sub_f32 v8, v8, v24
    v_sub_f32 v10, v10, v24
    v_sub_f32 v12, v12, v24
    v_mul_f32 v6, s64, v6
    v_mul_f32 v8, s64, v8
    v_mul_f32 v10, s64, v10
    v_mul_f32 v12, s64, v12
    v_exp_f32 v6, v6
    v_exp_f32 v8, v8
    v_exp_f32 v10, v10
    v_exp_f32 v12, v12
    s_waitcnt lgkmcnt(0)
    v_mul_f32 v18, v6, v14
    v_mul_f32 v25, v6, v7
    v_fmac_f32 v18, v8, v15
    v_fmac_f32 v25, v8, v9
    v_fmac_f32 v18, v10, v16
    v_fmac_f32 v25, v10, v11
    v_fmac_f32 v18, v12, v17
    v_fmac_f32 v25, v12, v13
    v_cvt_pk_bf16_f32 v18, v18, v18
    s_nop 1
    v_mov_b32_dpp v20, v18 row_newbcast:0 row_mask:0xf bank_mask:0x3
    v_mov_b32_dpp v20, v18 row_newbcast:8 row_mask:0xf bank_mask:0xc
    v_and_b32 v6, v20, v2
    v_and_b32 v7, v20, v3
    v_and_b32 v8, v20, v4
    v_and_b32 v9, v20, v5
    v_mov_b32_dpp v20, v18 row_newbcast:1 row_mask:0xf bank_mask:0x3
    v_mov_b32_dpp v20, v18 row_newbcast:9 row_mask:0xf bank_mask:0xc
    v_and_b32 v10, v20, v2
    v_and_b32 v11, v20, v3
    v_and_b32 v12, v20, v4
    v_and_b32 v13, v20, v5
    v_mfma_f32_16x16x32_bf16 v[14:17], v[6:9], v[32:35], 0
    v_mfma_f32_16x16x32_bf16 v[32:35], v[6:9], v[36:39], 0
    v_mfma_f32_16x16x32_bf16 v[36:39], v[6:9], v[40:43], 0
    v_mfma_f32_16x16x32_bf16 v[40:43], v[6:9], v[44:47], 0
    v_mfma_f32_16x16x32_bf16 v[44:47], v[6:9], v[48:51], 0
    v_mfma_f32_16x16x32_bf16 v[48:51], v[6:9], v[52:55], 0
    v_mfma_f32_16x16x32_bf16 v[52:55], v[6:9], v[56:59], 0
    v_mov_b32_dpp v20, v18 row_newbcast:2 row_mask:0xf bank_mask:0x3
    v_mov_b32_dpp v20, v18 row_newbcast:10 row_mask:0xf bank_mask:0xc
    v_and_b32 v6, v20, v2
    v_and_b32 v7, v20, v3
    v_and_b32 v8, v20, v4
    v_and_b32 v9, v20, v5
    v_mfma_f32_16x16x32_bf16 v[14:17], v[10:13], v[60:63], v[14:17]
    v_mfma_f32_16x16x32_bf16 v[32:35], v[10:13], v[64:67], v[32:35]
    v_mfma_f32_16x16x32_bf16 v[36:39], v[10:13], v[68:71], v[36:39]
    v_mfma_f32_16x16x32_bf16 v[40:43], v[10:13], v[72:75], v[40:43]
    v_mfma_f32_16x16x32_bf16 v[44:47], v[10:13], v[76:79], v[44:47]
    v_mfma_f32_16x16x32_bf16 v[48:51], v[10:13], v[80:83], v[48:51]
    v_mfma_f32_16x16x32_bf16 v[52:55], v[10:13], v[84:87], v[52:55]
    v_mov_b32_dpp v20, v18 row_newbcast:3 row_mask:0xf bank_mask:0x3
    v_mov_b32_dpp v20, v18 row_newbcast:11 row_mask:0xf bank_mask:0xc
    v_and_b32 v10, v20, v2
    v_and_b32 v11, v20, v3
    v_and_b32 v12, v20, v4
    v_and_b32 v13, v20, v5
    v_mfma_f32_16x16x32_bf16 v[14:17], v[6:9], v[88:91], v[14:17]
    v_mfma_f32_16x16x32_bf16 v[32:35], v[6:9], v[92:95], v[32:35]
    v_mfma_f32_16x16x32_bf16 v[36:39], v[6:9], v[96:99], v[36:39]
    v_mfma_f32_16x16x32_bf16 v[40:43], v[6:9], v[100:103], v[40:43]
    v_mfma_f32_16x16x32_bf16 v[44:47], v[6:9], v[104:107], v[44:47]
    v_mfma_f32_16x16x32_bf16 v[48:51], v[6:9], v[108:111], v[48:51]
    v_mfma_f32_16x16x32_bf16 v[52:55], v[6:9], v[112:115], v[52:55]
    v_mov_b32_dpp v20, v18 row_newbcast:4 row_mask:0xf bank_mask:0x3
    v_mov_b32_dpp v20, v18 row_newbcast:12 row_mask:0xf bank_mask:0xc
    v_and_b32 v6, v20, v2
    v_and_b32 v7, v20, v3
    v_and_b32 v8, v20, v4
    v_and_b32 v9, v20, v5
    v_mfma_f32_16x16x32_bf16 v[14:17], v[10:13], v[116:119], v[14:17]
    v_mfma_f32_16x16x32_bf16 v[32:35], v[10:13], v[120:123], v[32:35]
    v_mfma_f32_16x16x32_bf16 v[36:39], v[10:13], v[124:127], v[36:39]
    v_mfma_f32_16x16x32_bf16 v[40:43], v[10:13], v[128:131], v[40:43]
    v_mfma_f32_16x16x32_bf16 v[44:47], v[10:13], v[132:135], v[44:47]
    v_mfma_f32_16x16x32_bf16 v[48:51], v[10:13], v[136:139], v[48:51]
    v_mfma_f32_16x16x32_bf16 v[52:55], v[10:13], v[140:143], v[52:55]
    v_mov_b32_dpp v20, v18 row_newbcast:5 row_mask:0xf bank_mask:0x3
    v_mov_b32_dpp v20, v18 row_newbcast:13 row_mask:0xf bank_mask:0xc
    v_and_b32 v10, v20, v2
    v_and_b32 v11, v20, v3
    v_and_b32 v12, v20, v4
    v_and_b32 v13, v20, v5
    v_mfma_f32_16x16x32_bf16 v[14:17], v[6:9], v[144:147], v[14:17]
    v_mfma_f32_16x16x32_bf16 v[32:35], v[6:9], v[148:151], v[32:35]
    v_mfma_f32_16x16x32_bf16 v[36:39], v[6:9], v[152:155], v[36:39]
    v_mfma_f32_16x16x32_bf16 v[40:43], v[6:9], v[156:159], v[40:43]
    v_mfma_f32_16x16x32_bf16 v[44:47], v[6:9], v[160:163], v[44:47]
    v_mfma_f32_16x16x32_bf16 v[48:51], v[6:9], v[164:167], v[48:51]
    v_mfma_f32_16x16x32_bf16 v[52:55], v[6:9], v[168:171], v[52:55]
    v_mov_b32_dpp v20, v18 row_newbcast:6 row_mask:0xf bank_mask:0x3
    v_mov_b32_dpp v20, v18 row_newbcast:14 row_mask:0xf bank_mask:0xc
    v_and_b32 v6, v20, v2
    v_and_b32 v7, v20, v3
    v_and_b32 v8, v20, v4
    v_and_b32 v9, v20, v5
    v_mfma_f32_16x16x32_bf16 v[14:17], v[10:13], v[172:175], v[14:17]
    v_mfma_f32_16x16x32_bf16 v[32:35], v[10:13], v[176:179], v[32:35]
    v_mfma_f32_16x16x32_bf16 v[36:39], v[10:13], v[180:183], v[36:39]
    v_mfma_f32_16x16x32_bf16 v[40:43], v[10:13], v[184:187], v[40:43]
    v_mfma_f32_16x16x32_bf16 v[44:47], v[10:13], v[188:191], v[44:47]
    v_mfma_f32_16x16x32_bf16 v[48:51], v[10:13], v[192:195], v[48:51]
    v_mfma_f32_16x16x32_bf16 v[52:55], v[10:13], v[196:199], v[52:55]
    v_mov_b32_dpp v20, v18 row_newbcast:7 row_mask:0xf bank_mask:0x3
    v_mov_b32_dpp v20, v18 row_newbcast:15 row_mask:0xf bank_mask:0xc
    v_and_b32 v10, v20, v2
    v_and_b32 v11, v20, v3
    v_and_b32 v12, v20, v4
    v_and_b32 v13, v20, v5
    v_mfma_f32_16x16x32_bf16 v[14:17], v[6:9], v[200:203], v[14:17]
    v_mfma_f32_16x16x32_bf16 v[32:35], v[6:9], v[204:207], v[32:35]
    v_mfma_f32_16x16x32_bf16 v[36:39], v[6:9], v[208:211], v[36:39]
    v_mfma_f32_16x16x32_bf16 v[40:43], v[6:9], v[212:215], v[40:43]
    v_mfma_f32_16x16x32_bf16 v[44:47], v[6:9], v[216:219], v[44:47]
    v_mfma_f32_16x16x32_bf16 v[48:51], v[6:9], v[220:223], v[48:51]
    v_mfma_f32_16x16x32_bf16 v[52:55], v[6:9], v[224:227], v[52:55]
    s_nop 1
    v_mfma_f32_16x16x32_bf16 v[14:17], v[10:13], v[228:231], v[14:17]
    v_mfma_f32_16x16x32_bf16 v[32:35], v[10:13], v[232:235], v[32:35]
    v_mfma_f32_16x16x32_bf16 v[36:39], v[10:13], v[236:239], v[36:39]
    v_mfma_f32_16x16x32_bf16 v[40:43], v[10:13], v[240:243], v[40:43]
    v_mfma_f32_16x16x32_bf16 v[44:47], v[10:13], v[244:247], v[44:47]
    v_mfma_f32_16x16x32_bf16 v[48:51], v[10:13], v[248:251], v[48:51]
    v_mfma_f32_16x16x32_bf16 v[52:55], v[10:13], v[252:255], v[52:55]
    s_nop 7
    v_permlane32_swap_b32 v14, v32
    v_permlane32_swap_b32 v15, v33
    v_permlane32_swap_b32 v16, v34
    v_permlane32_swap_b32 v17, v35
    v_permlane32_swap_b32 v36, v40
    v_permlane32_swap_b32 v37, v41
    v_permlane32_swap_b32 v38, v42
    v_permlane32_swap_b32 v39, v43
    v_permlane32_swap_b32 v44, v48
    v_permlane32_swap_b32 v45, v49
    v_permlane32_swap_b32 v46, v50
    v_permlane32_swap_b32 v47, v51
    v_permlane32_swap_b32 v52, v56
    v_permlane32_swap_b32 v53, v57
    v_permlane32_swap_b32 v54, v58
    v_permlane32_swap_b32 v55, v59
    s_nop 0
    v_add_f32_dpp v14, v32, v14 row_ror:8 row_mask:0xf bank_mask:0xf
    v_add_f32_dpp v15, v33, v15 row_ror:8 row_mask:0xf bank_mask:0xf
    v_add_f32_dpp v16, v34, v16 row_ror:8 row_mask:0xf bank_mask:0xf
    v_add_f32_dpp v17, v35, v17 row_ror:8 row_mask:0xf bank_mask:0xf
    v_add_f32_dpp v36, v40, v36 row_ror:8 row_mask:0xf bank_mask:0xf
    v_add_f32_dpp v37, v41, v37 row_ror:8 row_mask:0xf bank_mask:0xf
    v_add_f32_dpp v38, v42, v38 row_ror:8 row_mask:0xf bank_mask:0xf
    v_add_f32_dpp v39, v43, v39 row_ror:8 row_mask:0xf bank_mask:0xf
    v_add_f32_dpp v44, v48, v44 row_ror:8 row_mask:0xf bank_mask:0xf
    v_add_f32_dpp v45, v49, v45 row_ror:8 row_mask:0xf bank_mask:0xf
    v_add_f32_dpp v46, v50, v46 row_ror:8 row_mask:0xf bank_mask:0xf
    v_add_f32_dpp v47, v51, v47 row_ror:8 row_mask:0xf bank_mask:0xf
    v_add_f32_dpp v52, v56, v52 row_ror:8 row_mask:0xf bank_mask:0xf
    v_add_f32_dpp v53, v57, v53 row_ror:8 row_mask:0xf bank_mask:0xf
    v_add_f32_dpp v54, v58, v54 row_ror:8 row_mask:0xf bank_mask:0xf
    v_add_f32_dpp v55, v59, v55 row_ror:8 row_mask:0xf bank_mask:0xf
    s_mov_b64 exec, s[36:37]
    ds_write_b128 v23, v[14:17] offset:16384
    ds_write_b128 v23, v[36:39] offset:16896
    ds_write_b128 v23, v[44:47] offset:17408
    ds_write_b128 v23, v[52:55] offset:17920
    s_mov_b64 exec, -1
    s_waitcnt lgkmcnt(0)
    s_barrier
    s_cmp_ge_u32 s26, 2
    s_cbranch_scc1 L_end
    ds_read_b64 v[96:97], v29 offset:0
    ds_read_b64 v[98:99], v29 offset:8
    ds_read_b64 v[100:101], v29 offset:2048
    ds_read_b64 v[102:103], v29 offset:2056
    ds_read_b64 v[104:105], v29 offset:4096
    ds_read_b64 v[106:107], v29 offset:4104
    ds_read_b64 v[108:109], v29 offset:6144
    ds_read_b64 v[110:111], v29 offset:6152
    s_waitcnt lgkmcnt(4)
    v_pk_add_f32 v[96:97], v[96:97], v[100:101]
    v_pk_add_f32 v[98:99], v[98:99], v[102:103]
    s_waitcnt lgkmcnt(0)
    v_pk_add_f32 v[104:105], v[104:105], v[108:109]
    v_pk_add_f32 v[106:107], v[106:107], v[110:111]
    v_pk_add_f32 v[96:97], v[96:97], v[104:105]
    v_pk_add_f32 v[98:99], v[98:99], v[106:107]
    v_cndmask_b32 v98, v98, v24, s[38:39]
    v_cndmask_b32 v99, v99, v25, s[38:39]
    v_add_u32 v96, 0x200, v96
    v_add_u32 v97, 0x200, v97
    v_add_u32 v98, 0x200, v98
    v_add_u32 v99, 0x200, v99
    v_and_or_b32 v96, v96, s35, v31
    v_and_or_b32 v97, v97, s35, v31
    v_and_or_b32 v98, v98, s35, v31
    v_and_or_b32 v99, v99, s35, v31
    buffer_store_dwordx4 v[96:99], v30, s[20:23], s33 offen sc1
L_fin:
L_end:
    s_endpgm
.section .rodata,"a"
.p2align 6
.amdhsa_kernel recurrent_scan__mha_block_cached__geglu_ffn__decode_kernel
  .amdhsa_next_free_vgpr 256
  .amdhsa_next_free_sgpr 102
  .amdhsa_accum_offset 256
  .amdhsa_group_segment_fixed_size 0
  .amdhsa_kernarg_size 96
  .amdhsa_user_sgpr_count 2
  .amdhsa_user_sgpr_kernarg_segment_ptr 1
  .amdhsa_system_sgpr_workgroup_id_x 1
.end_amdhsa_kernel
```
